```python
import torch

def _softmax(x, axis=-1):
    return torch.softmax(x, dim=axis)
def _gelu(x):
    return torch.nn.functional.gelu(x, approximate="tanh")
def _silu(x):
    return torch.nn.functional.silu(x)
def _sigmoid(x):
    return torch.sigmoid(x)
def _layernorm(x, axis=-1, eps=1e-5):
    m = x.mean(dim=axis, keepdim=True)
    v = x.var(dim=axis, keepdim=True, unbiased=False)
    return (x - m) / torch.sqrt(v + eps)
def _scatter_add(tgt, idx, src, axis=0):
    return tgt.clone().index_add_(axis, idx, src)
def _segment_sum(src, seg, n):
    out = torch.zeros((n,) + src.shape[1:], dtype=src.dtype)
    return out.index_add_(0, seg, src)
def _pad(x, pw):
    flat = tuple(v for pair in reversed(pw) for v in pair)
    return torch.nn.functional.pad(x, flat)

kernel_name = 'sequential_preLN__linear_attn_block__mixer_s_mlp__prompt'

def setup_inputs():

    _w = (lambda a: (lambda t: t.to(torch.bfloat16) if t.is_floating_point() else t)(torch.as_tensor(a)))
    def _A_setup():
        B, S, D = 1, 2048, 640
        return {
            "x": _w((lambda *s: torch.randn(*s, dtype=torch.bfloat16) * 0.05)(B, S, D)),
            "wqkv": _w((lambda *s: torch.randn(*s, dtype=torch.bfloat16) * 0.05)(D, 3 * D)),
            "wo": _w((lambda *s: torch.randn(*s, dtype=torch.bfloat16) * 0.05)(D, D)),
        }
    _A_in = _A_setup()

    def _B_setup():
        B, S, D, F = 1, 2048, 640, 1536
        return {
            "x":  _w((lambda *s: torch.randn(*s, dtype=torch.bfloat16) * 0.05)(B, S, D)),
            "w1": _w((lambda *s: torch.randn(*s, dtype=torch.bfloat16) * 3.2)(D, D) * (D ** -0.5)),
            "w2": _w((lambda *s: torch.randn(*s, dtype=torch.bfloat16) * 3.2)(D, D) * (D ** -0.5)),
            "w3": _w((lambda *s: torch.randn(*s, dtype=torch.bfloat16) * 3.2)(D, F) * (D ** -0.5)),
            "w4": _w((lambda *s: torch.randn(*s, dtype=torch.bfloat16) * 3.2)(F, D) * (F ** -0.5)),
        }
    _B_in = _B_setup()

    return {
        "A_x": _A_in["x"],
        "A_wqkv": _A_in["wqkv"],
        "A_wo": _A_in["wo"],
        "B_x": _B_in["x"],
        "B_w1": _B_in["w1"],
        "B_w2": _B_in["w2"],
        "B_w3": _B_in["w3"],
        "B_w4": _B_in["w4"],
    }

def reference(A_x, A_wqkv, A_wo, B_x, B_w1, B_w2, B_w3, B_w4):
    def _A_ref(x, wqkv, wo):
        B, S, D = x.shape
        H = 32; Dh = D // H
        qkv = (lambda x, *d: x.permute(*d))((x @ wqkv).reshape(B, S, 3, H, Dh), 2, 0, 3, 1, 4)
        q, k, v = qkv[0], qkv[1], qkv[2]
        phi = lambda t: torch.where(t > 0, t + 1, torch.exp(t)) + 1e-6
        pq, pk = phi(q), phi(k)
        kv = torch.einsum("bhsd,bhse->bhde", pk, v)
        z = torch.einsum("bhsd->bhd", pk)
        num = torch.einsum("bhqd,bhde->bhqe", pq, kv)
        den = torch.einsum("bhqd,bhd->bhq", pq, z)[..., None] + 1e-6
        o = num / den
        return (lambda x, *d: x.permute(*d))(o, 0, 2, 1, 3).reshape(B, S, D) @ wo

    def _B_ref(x, w1, w2, w3, w4):
        B, S, D = x.shape
        h = _gelu(_layernorm(x, axis=-1) @ w1)
        c = D // 4
        g0 = _pad(h[:, :, 0*c:1*c], ((0, 0), (1, 0), (0, 0)))[:, :S, :]
        g1 = _pad(h[:, :, 1*c:2*c], ((0, 0), (0, 1), (0, 0)))[:, 1:, :]
        g2 = _pad(h[:, :, 2*c:3*c], ((0, 0), (2, 0), (0, 0)))[:, :S, :]
        g3 = _pad(h[:, :, 3*c:   ], ((0, 0), (0, 2), (0, 0)))[:, 2:, :]
        hs = torch.concatenate([g0, g1, g2, g3], axis=-1) @ w2
        x1 = x + hs
        h2 = _gelu(_layernorm(x1, axis=-1) @ w3) @ w4
        return x1 + h2

    x = A_x
    h = x + _A_ref(_layernorm(x, axis=-1), A_wqkv, A_wo)
    h2 = h + _B_ref(_layernorm(h, axis=-1), B_w1, B_w2, B_w3, B_w4)
    return h2
```

```asm
; @launch kernel=k1_kernel grid=(256,1,1) block=(256,1,1) lds=153600
; @launch kernel=k1b_kernel grid=(256,1,1) block=(256,1,1) lds=153600
; @launch kernel=k2_kernel grid=(256,1,1) block=(256,1,1) lds=153600
; @launch kernel=k3_kernel grid=(256,1,1) block=(256,1,1) lds=153600
; @launch kernel=k4_kernel grid=(256,1,1) block=(256,1,1) lds=153600
; @launch kernel=k5_kernel grid=(256,1,1) block=(256,1,1) lds=153600
; @launch kernel=k6_kernel grid=(256,1,1) block=(256,1,1) lds=153600
.amdgcn_target "amdgcn-amd-amdhsa--gfx950"
.text
.p2align 8
.globl k1_kernel
.type k1_kernel,@function
k1_kernel:
s_cmp_ge_u32 s2, 256
s_cbranch_scc1 k1_kernel_end
s_load_dwordx16 s[16:31], s[0:1], 0
s_load_dwordx4 s[32:35], s[0:1], 64
s_load_dwordx2 s[36:37], s[0:1], 80
s_mov_b32 s40, 0x3d372713
s_mov_b32 s41, 0xc0135761
s_mov_b32 s42, 0x3acccccd
v_and_b32 v252, 63, v0
v_lshrrev_b32 v253, 6, v0
s_nop 0
v_readfirstlane_b32 s3, v253
v_and_b32 v253, 15, v252
v_lshrrev_b32 v254, 4, v252
v_xor_b32 v250, 16, v252
v_lshlrev_b32 v250, 2, v250
v_xor_b32 v251, 32, v252
v_lshlrev_b32 v251, 2, v251
s_and_b32 s4, s2, 7
s_lshl_b32 s4, s4, 2
s_lshr_b32 s5, s2, 3
s_and_b32 s6, s5, 3
s_add_u32 s4, s4, s6
s_lshr_b32 s5, s5, 2
s_lshl_b32 s6, s4, 6
s_lshl_b32 s7, s3, 4
s_add_u32 s6, s6, s7
v_add_u32 v255, s6, v253
s_waitcnt lgkmcnt(0)
s_mov_b32 s44, s16
s_mov_b32 s45, s17
s_mov_b32 s46, 2621440
s_mov_b32 s47, 0x00020000
s_mov_b32 s48, s18
s_mov_b32 s49, s19
s_mov_b32 s50, 2457600
s_mov_b32 s51, 0x00020000
s_mul_i32 s8, s3, 8192
v_lshlrev_b32 v240, 4, v252
v_add_u32 v240, s8, v240
v_add_u32 v240, 0, v240
v_cvt_f32_u32 v241, v240
s_mov_b32 s9, 0x3b088889
v_add_f32 v241, 0.5, v241
v_mul_f32 v241, s9, v241
v_cvt_u32_f32 v241, v241
s_movk_i32 s9, 480
v_mul_lo_u32 v242, v241, s9
v_sub_u32 v242, v240, v242
v_cmp_le_u32 vcc, 160, v242
s_nop 1
v_cndmask_b32 v243, 0, 1, vcc
v_cmp_le_u32 vcc, 320, v242
s_nop 1
v_addc_co_u32 v243, vcc, 0, v243, vcc
s_movk_i32 s9, 1120
v_mad_u32_u24 v242, v243, s9, v242
s_movk_i32 s9, 3840
v_mad_u32_u24 v192, v241, s9, v242
s_mul_i32 s8, s3, 8192
v_lshlrev_b32 v240, 4, v252
v_add_u32 v240, s8, v240
v_add_u32 v240, 1024, v240
v_cvt_f32_u32 v241, v240
s_mov_b32 s9, 0x3b088889
v_add_f32 v241, 0.5, v241
v_mul_f32 v241, s9, v241
v_cvt_u32_f32 v241, v241
s_movk_i32 s9, 480
v_mul_lo_u32 v242, v241, s9
v_sub_u32 v242, v240, v242
v_cmp_le_u32 vcc, 160, v242
s_nop 1
v_cndmask_b32 v243, 0, 1, vcc
v_cmp_le_u32 vcc, 320, v242
s_nop 1
v_addc_co_u32 v243, vcc, 0, v243, vcc
s_movk_i32 s9, 1120
v_mad_u32_u24 v242, v243, s9, v242
s_movk_i32 s9, 3840
v_mad_u32_u24 v193, v241, s9, v242
s_mul_i32 s8, s3, 8192
v_lshlrev_b32 v240, 4, v252
v_add_u32 v240, s8, v240
v_add_u32 v240, 2048, v240
v_cvt_f32_u32 v241, v240
s_mov_b32 s9, 0x3b088889
v_add_f32 v241, 0.5, v241
v_mul_f32 v241, s9, v241
v_cvt_u32_f32 v241, v241
s_movk_i32 s9, 480
v_mul_lo_u32 v242, v241, s9
v_sub_u32 v242, v240, v242
v_cmp_le_u32 vcc, 160, v242
s_nop 1
v_cndmask_b32 v243, 0, 1, vcc
v_cmp_le_u32 vcc, 320, v242
s_nop 1
v_addc_co_u32 v243, vcc, 0, v243, vcc
s_movk_i32 s9, 1120
v_mad_u32_u24 v242, v243, s9, v242
s_movk_i32 s9, 3840
v_mad_u32_u24 v194, v241, s9, v242
s_mul_i32 s8, s3, 8192
v_lshlrev_b32 v240, 4, v252
v_add_u32 v240, s8, v240
v_add_u32 v240, 3072, v240
v_cvt_f32_u32 v241, v240
s_mov_b32 s9, 0x3b088889
v_add_f32 v241, 0.5, v241
v_mul_f32 v241, s9, v241
v_cvt_u32_f32 v241, v241
s_movk_i32 s9, 480
v_mul_lo_u32 v242, v241, s9
v_sub_u32 v242, v240, v242
v_cmp_le_u32 vcc, 160, v242
s_nop 1
v_cndmask_b32 v243, 0, 1, vcc
v_cmp_le_u32 vcc, 320, v242
s_nop 1
v_addc_co_u32 v243, vcc, 0, v243, vcc
s_movk_i32 s9, 1120
v_mad_u32_u24 v242, v243, s9, v242
s_movk_i32 s9, 3840
v_mad_u32_u24 v195, v241, s9, v242
s_mul_i32 s8, s3, 8192
v_lshlrev_b32 v240, 4, v252
v_add_u32 v240, s8, v240
v_add_u32 v240, 4096, v240
v_cvt_f32_u32 v241, v240
s_mov_b32 s9, 0x3b088889
v_add_f32 v241, 0.5, v241
v_mul_f32 v241, s9, v241
v_cvt_u32_f32 v241, v241
s_movk_i32 s9, 480
v_mul_lo_u32 v242, v241, s9
v_sub_u32 v242, v240, v242
v_cmp_le_u32 vcc, 160, v242
s_nop 1
v_cndmask_b32 v243, 0, 1, vcc
v_cmp_le_u32 vcc, 320, v242
s_nop 1
v_addc_co_u32 v243, vcc, 0, v243, vcc
s_movk_i32 s9, 1120
v_mad_u32_u24 v242, v243, s9, v242
s_movk_i32 s9, 3840
v_mad_u32_u24 v196, v241, s9, v242
s_mul_i32 s8, s3, 8192
v_lshlrev_b32 v240, 4, v252
v_add_u32 v240, s8, v240
v_add_u32 v240, 5120, v240
v_cvt_f32_u32 v241, v240
s_mov_b32 s9, 0x3b088889
v_add_f32 v241, 0.5, v241
v_mul_f32 v241, s9, v241
v_cvt_u32_f32 v241, v241
s_movk_i32 s9, 480
v_mul_lo_u32 v242, v241, s9
v_sub_u32 v242, v240, v242
v_cmp_le_u32 vcc, 160, v242
s_nop 1
v_cndmask_b32 v243, 0, 1, vcc
v_cmp_le_u32 vcc, 320, v242
s_nop 1
v_addc_co_u32 v243, vcc, 0, v243, vcc
s_movk_i32 s9, 1120
v_mad_u32_u24 v242, v243, s9, v242
s_movk_i32 s9, 3840
v_mad_u32_u24 v197, v241, s9, v242
s_mul_i32 s8, s3, 8192
v_lshlrev_b32 v240, 4, v252
v_add_u32 v240, s8, v240
v_add_u32 v240, 6144, v240
v_cvt_f32_u32 v241, v240
s_mov_b32 s9, 0x3b088889
v_add_f32 v241, 0.5, v241
v_mul_f32 v241, s9, v241
v_cvt_u32_f32 v241, v241
s_movk_i32 s9, 480
v_mul_lo_u32 v242, v241, s9
v_sub_u32 v242, v240, v242
v_cmp_le_u32 vcc, 160, v242
s_nop 1
v_cndmask_b32 v243, 0, 1, vcc
v_cmp_le_u32 vcc, 320, v242
s_nop 1
v_addc_co_u32 v243, vcc, 0, v243, vcc
s_movk_i32 s9, 1120
v_mad_u32_u24 v242, v243, s9, v242
s_movk_i32 s9, 3840
v_mad_u32_u24 v198, v241, s9, v242
s_mul_i32 s8, s3, 8192
v_lshlrev_b32 v240, 4, v252
v_add_u32 v240, s8, v240
v_add_u32 v240, 7168, v240
v_cvt_f32_u32 v241, v240
s_mov_b32 s9, 0x3b088889
v_add_f32 v241, 0.5, v241
v_mul_f32 v241, s9, v241
v_cvt_u32_f32 v241, v241
s_movk_i32 s9, 480
v_mul_lo_u32 v242, v241, s9
v_sub_u32 v242, v240, v242
v_cmp_le_u32 vcc, 160, v242
s_nop 1
v_cndmask_b32 v243, 0, 1, vcc
v_cmp_le_u32 vcc, 320, v242
s_nop 1
v_addc_co_u32 v243, vcc, 0, v243, vcc
s_movk_i32 s9, 1120
v_mad_u32_u24 v242, v243, s9, v242
s_movk_i32 s9, 3840
v_mad_u32_u24 v199, v241, s9, v242
s_mul_i32 s10, s5, 160
s_mul_i32 s13, s3, 8192
s_add_u32 s13, s13, 81920
s_mov_b32 s14, 0
v_and_b32 v240, 1, v254
v_mov_b32 v241, 0
v_lshl_add_u32 v241, v254, 4, v241
s_movk_i32 s9, 1280
v_mad_u32_u24 v248, v255, s9, v241
v_mov_b32 v241, 8
v_lshl_add_u32 v241, v254, 4, v241
s_movk_i32 s9, 1280
v_mad_u32_u24 v249, v255, s9, v241
v_accvgpr_write_b32 a0, 0
v_accvgpr_write_b32 a1, 0
v_accvgpr_write_b32 a2, 0
v_accvgpr_write_b32 a3, 0
v_accvgpr_write_b32 a4, 0
v_accvgpr_write_b32 a5, 0
v_accvgpr_write_b32 a6, 0
v_accvgpr_write_b32 a7, 0
v_accvgpr_write_b32 a8, 0
v_accvgpr_write_b32 a9, 0
v_accvgpr_write_b32 a10, 0
v_accvgpr_write_b32 a11, 0
v_accvgpr_write_b32 a12, 0
v_accvgpr_write_b32 a13, 0
v_accvgpr_write_b32 a14, 0
v_accvgpr_write_b32 a15, 0
v_accvgpr_write_b32 a16, 0
v_accvgpr_write_b32 a17, 0
v_accvgpr_write_b32 a18, 0
v_accvgpr_write_b32 a19, 0
v_accvgpr_write_b32 a20, 0
v_accvgpr_write_b32 a21, 0
v_accvgpr_write_b32 a22, 0
v_accvgpr_write_b32 a23, 0
v_accvgpr_write_b32 a24, 0
v_accvgpr_write_b32 a25, 0
v_accvgpr_write_b32 a26, 0
v_accvgpr_write_b32 a27, 0
v_accvgpr_write_b32 a28, 0
v_accvgpr_write_b32 a29, 0
v_accvgpr_write_b32 a30, 0
v_accvgpr_write_b32 a31, 0
v_accvgpr_write_b32 a32, 0
v_accvgpr_write_b32 a33, 0
v_accvgpr_write_b32 a34, 0
v_accvgpr_write_b32 a35, 0
v_accvgpr_write_b32 a36, 0
v_accvgpr_write_b32 a37, 0
v_accvgpr_write_b32 a38, 0
v_accvgpr_write_b32 a39, 0
v_accvgpr_write_b32 a40, 0
v_accvgpr_write_b32 a41, 0
v_accvgpr_write_b32 a42, 0
v_accvgpr_write_b32 a43, 0
v_accvgpr_write_b32 a44, 0
v_accvgpr_write_b32 a45, 0
v_accvgpr_write_b32 a46, 0
v_accvgpr_write_b32 a47, 0
v_accvgpr_write_b32 a48, 0
v_accvgpr_write_b32 a49, 0
v_accvgpr_write_b32 a50, 0
v_accvgpr_write_b32 a51, 0
v_accvgpr_write_b32 a52, 0
v_accvgpr_write_b32 a53, 0
v_accvgpr_write_b32 a54, 0
v_accvgpr_write_b32 a55, 0
v_accvgpr_write_b32 a56, 0
v_accvgpr_write_b32 a57, 0
v_accvgpr_write_b32 a58, 0
v_accvgpr_write_b32 a59, 0
v_lshlrev_b32 v236, 4, v252
s_mul_i32 s8, s3, 20480
v_add_u32 v236, s8, v236
s_mul_i32 s8, s3, 20480
s_add_u32 m0, s8, 0
s_movk_i32 s9, 0
buffer_load_dwordx4 v248, s[44:47], s9 offen lds
s_mul_i32 s8, s3, 20480
s_add_u32 m0, s8, 1024
s_movk_i32 s9, 64
buffer_load_dwordx4 v248, s[44:47], s9 offen lds
s_mul_i32 s8, s3, 20480
s_add_u32 m0, s8, 2048
s_movk_i32 s9, 128
buffer_load_dwordx4 v248, s[44:47], s9 offen lds
s_mul_i32 s8, s3, 20480
s_add_u32 m0, s8, 3072
s_movk_i32 s9, 192
buffer_load_dwordx4 v248, s[44:47], s9 offen lds
s_mul_i32 s8, s3, 20480
s_add_u32 m0, s8, 4096
s_movk_i32 s9, 256
buffer_load_dwordx4 v248, s[44:47], s9 offen lds
s_mul_i32 s8, s3, 20480
s_add_u32 m0, s8, 5120
s_movk_i32 s9, 320
buffer_load_dwordx4 v248, s[44:47], s9 offen lds
s_mul_i32 s8, s3, 20480
s_add_u32 m0, s8, 6144
s_movk_i32 s9, 384
buffer_load_dwordx4 v248, s[44:47], s9 offen lds
s_mul_i32 s8, s3, 20480
s_add_u32 m0, s8, 7168
s_movk_i32 s9, 448
buffer_load_dwordx4 v248, s[44:47], s9 offen lds
s_mul_i32 s8, s3, 20480
s_add_u32 m0, s8, 8192
s_movk_i32 s9, 512
buffer_load_dwordx4 v248, s[44:47], s9 offen lds
s_mul_i32 s8, s3, 20480
s_add_u32 m0, s8, 9216
s_movk_i32 s9, 576
buffer_load_dwordx4 v248, s[44:47], s9 offen lds
s_mul_i32 s8, s3, 20480
s_add_u32 m0, s8, 10240
s_movk_i32 s9, 640
buffer_load_dwordx4 v248, s[44:47], s9 offen lds
s_mul_i32 s8, s3, 20480
s_add_u32 m0, s8, 11264
s_movk_i32 s9, 704
buffer_load_dwordx4 v248, s[44:47], s9 offen lds
s_mul_i32 s8, s3, 20480
s_add_u32 m0, s8, 12288
s_movk_i32 s9, 768
buffer_load_dwordx4 v248, s[44:47], s9 offen lds
s_mul_i32 s8, s3, 20480
s_add_u32 m0, s8, 13312
s_movk_i32 s9, 832
buffer_load_dwordx4 v248, s[44:47], s9 offen lds
s_mul_i32 s8, s3, 20480
s_add_u32 m0, s8, 14336
s_movk_i32 s9, 896
buffer_load_dwordx4 v248, s[44:47], s9 offen lds
s_mul_i32 s8, s3, 20480
s_add_u32 m0, s8, 15360
s_movk_i32 s9, 960
buffer_load_dwordx4 v248, s[44:47], s9 offen lds
s_mul_i32 s8, s3, 20480
s_add_u32 m0, s8, 16384
s_movk_i32 s9, 1024
buffer_load_dwordx4 v248, s[44:47], s9 offen lds
s_mul_i32 s8, s3, 20480
s_add_u32 m0, s8, 17408
s_movk_i32 s9, 1088
buffer_load_dwordx4 v248, s[44:47], s9 offen lds
s_mul_i32 s8, s3, 20480
s_add_u32 m0, s8, 18432
s_movk_i32 s9, 1152
buffer_load_dwordx4 v248, s[44:47], s9 offen lds
s_mul_i32 s8, s3, 20480
s_add_u32 m0, s8, 19456
s_movk_i32 s9, 1216
buffer_load_dwordx4 v248, s[44:47], s9 offen lds
s_add_u32 s8, s13, s14
s_add_u32 m0, s8, 0
s_nop 0
buffer_load_dwordx4 v192, s[48:51], s10 offen lds
s_add_u32 s8, s13, s14
s_add_u32 m0, s8, 1024
s_nop 0
buffer_load_dwordx4 v193, s[48:51], s10 offen lds
s_add_u32 s8, s13, s14
s_add_u32 m0, s8, 2048
s_nop 0
buffer_load_dwordx4 v194, s[48:51], s10 offen lds
s_add_u32 s8, s13, s14
s_add_u32 m0, s8, 3072
s_nop 0
buffer_load_dwordx4 v195, s[48:51], s10 offen lds
s_add_u32 s8, s13, s14
s_add_u32 m0, s8, 4096
s_nop 0
buffer_load_dwordx4 v196, s[48:51], s10 offen lds
s_add_u32 s8, s13, s14
s_add_u32 m0, s8, 5120
s_nop 0
buffer_load_dwordx4 v197, s[48:51], s10 offen lds
s_add_u32 s8, s13, s14
s_add_u32 m0, s8, 6144
s_nop 0
buffer_load_dwordx4 v198, s[48:51], s10 offen lds
s_add_u32 s8, s13, s14
s_add_u32 m0, s8, 7168
s_nop 0
buffer_load_dwordx4 v199, s[48:51], s10 offen lds
s_add_u32 s10, s10, 245760
s_add_u32 s14, s14, 32768
s_cmp_ge_u32 s14, 65536
s_cselect_b32 s14, 0, s14
v_mov_b32 v240, 0
v_mov_b32 v241, 0
s_waitcnt vmcnt(8)
s_waitcnt lgkmcnt(0)
v_mov_b32 v240, 0
v_mov_b32 v241, 0
s_mov_b32 s9, 0
k1_kernel_axs:
v_add_u32 v237, s9, v236
ds_read_b128 v[0:3], v237 offset:0
ds_read_b128 v[4:7], v237 offset:1024
ds_read_b128 v[8:11], v237 offset:2048
ds_read_b128 v[12:15], v237 offset:3072
s_waitcnt lgkmcnt(0)
v_lshlrev_b32 v242, 16, v0
v_and_b32 v243, 0xffff0000, v0
v_add_f32 v240, v240, v242
v_add_f32 v240, v240, v243
v_fmac_f32 v241, v242, v242
v_fmac_f32 v241, v243, v243
v_lshlrev_b32 v242, 16, v1
v_and_b32 v243, 0xffff0000, v1
v_add_f32 v240, v240, v242
v_add_f32 v240, v240, v243
v_fmac_f32 v241, v242, v242
v_fmac_f32 v241, v243, v243
v_lshlrev_b32 v242, 16, v2
v_and_b32 v243, 0xffff0000, v2
v_add_f32 v240, v240, v242
v_add_f32 v240, v240, v243
v_fmac_f32 v241, v242, v242
v_fmac_f32 v241, v243, v243
v_lshlrev_b32 v242, 16, v3
v_and_b32 v243, 0xffff0000, v3
v_add_f32 v240, v240, v242
v_add_f32 v240, v240, v243
v_fmac_f32 v241, v242, v242
v_fmac_f32 v241, v243, v243
v_lshlrev_b32 v242, 16, v4
v_and_b32 v243, 0xffff0000, v4
v_add_f32 v240, v240, v242
v_add_f32 v240, v240, v243
v_fmac_f32 v241, v242, v242
v_fmac_f32 v241, v243, v243
v_lshlrev_b32 v242, 16, v5
v_and_b32 v243, 0xffff0000, v5
v_add_f32 v240, v240, v242
v_add_f32 v240, v240, v243
v_fmac_f32 v241, v242, v242
v_fmac_f32 v241, v243, v243
v_lshlrev_b32 v242, 16, v6
v_and_b32 v243, 0xffff0000, v6
v_add_f32 v240, v240, v242
v_add_f32 v240, v240, v243
v_fmac_f32 v241, v242, v242
v_fmac_f32 v241, v243, v243
v_lshlrev_b32 v242, 16, v7
v_and_b32 v243, 0xffff0000, v7
v_add_f32 v240, v240, v242
v_add_f32 v240, v240, v243
v_fmac_f32 v241, v242, v242
v_fmac_f32 v241, v243, v243
v_lshlrev_b32 v242, 16, v8
v_and_b32 v243, 0xffff0000, v8
v_add_f32 v240, v240, v242
v_add_f32 v240, v240, v243
v_fmac_f32 v241, v242, v242
v_fmac_f32 v241, v243, v243
v_lshlrev_b32 v242, 16, v9
v_and_b32 v243, 0xffff0000, v9
v_add_f32 v240, v240, v242
v_add_f32 v240, v240, v243
v_fmac_f32 v241, v242, v242
v_fmac_f32 v241, v243, v243
v_lshlrev_b32 v242, 16, v10
v_and_b32 v243, 0xffff0000, v10
v_add_f32 v240, v240, v242
v_add_f32 v240, v240, v243
v_fmac_f32 v241, v242, v242
v_fmac_f32 v241, v243, v243
v_lshlrev_b32 v242, 16, v11
v_and_b32 v243, 0xffff0000, v11
v_add_f32 v240, v240, v242
v_add_f32 v240, v240, v243
v_fmac_f32 v241, v242, v242
v_fmac_f32 v241, v243, v243
v_lshlrev_b32 v242, 16, v12
v_and_b32 v243, 0xffff0000, v12
v_add_f32 v240, v240, v242
v_add_f32 v240, v240, v243
v_fmac_f32 v241, v242, v242
v_fmac_f32 v241, v243, v243
v_lshlrev_b32 v242, 16, v13
v_and_b32 v243, 0xffff0000, v13
v_add_f32 v240, v240, v242
v_add_f32 v240, v240, v243
v_fmac_f32 v241, v242, v242
v_fmac_f32 v241, v243, v243
v_lshlrev_b32 v242, 16, v14
v_and_b32 v243, 0xffff0000, v14
v_add_f32 v240, v240, v242
v_add_f32 v240, v240, v243
v_fmac_f32 v241, v242, v242
v_fmac_f32 v241, v243, v243
v_lshlrev_b32 v242, 16, v15
v_and_b32 v243, 0xffff0000, v15
v_add_f32 v240, v240, v242
v_add_f32 v240, v240, v243
v_fmac_f32 v241, v242, v242
v_fmac_f32 v241, v243, v243
s_add_u32 s9, s9, 4096
s_cmp_lt_u32 s9, 20480
s_cbranch_scc1 k1_kernel_axs
ds_bpermute_b32 v244, v250, v240
s_waitcnt lgkmcnt(0)
v_add_f32 v240, v240, v244
ds_bpermute_b32 v244, v251, v240
s_waitcnt lgkmcnt(0)
v_add_f32 v240, v240, v244
ds_bpermute_b32 v244, v250, v241
s_waitcnt lgkmcnt(0)
v_add_f32 v241, v241, v244
ds_bpermute_b32 v244, v251, v241
s_waitcnt lgkmcnt(0)
v_add_f32 v241, v241, v244
v_mul_f32 v240, s42, v240
v_mul_f32 v241, s42, v241
v_fma_f32 v241, -v240, v240, v241
v_max_f32 v241, 0, v241
v_cvt_pk_bf16_f32 v240, v240, v240
v_and_b32 v240, 0xffff0000, v240
v_cvt_pk_bf16_f32 v241, v241, v241
v_and_b32 v241, 0xffff0000, v241
v_add_f32 v241, 0x3727c5ac, v241
v_cvt_pk_bf16_f32 v241, v241, v241
v_and_b32 v241, 0xffff0000, v241
v_sqrt_f32 v241, v241
s_nop 0
v_cvt_pk_bf16_f32 v241, v241, v241
v_and_b32 v241, 0xffff0000, v241
v_rcp_f32 v241, v241
s_mov_b32 s9, 0
k1_kernel_axn:
v_add_u32 v237, s9, v236
ds_read_b128 v[0:3], v237 offset:0
ds_read_b128 v[4:7], v237 offset:1024
ds_read_b128 v[8:11], v237 offset:2048
ds_read_b128 v[12:15], v237 offset:3072
s_waitcnt lgkmcnt(0)
v_lshlrev_b32 v242, 16, v0
v_and_b32 v243, 0xffff0000, v0
v_sub_f32 v242, v242, v240
v_sub_f32 v243, v243, v240
v_cvt_pk_bf16_f32 v244, v242, v243
v_lshlrev_b32 v242, 16, v244
v_and_b32 v243, 0xffff0000, v244
v_mul_f32 v242, v242, v241
v_mul_f32 v243, v243, v241
v_cvt_pk_bf16_f32 v0, v242, v243
v_lshlrev_b32 v242, 16, v1
v_and_b32 v243, 0xffff0000, v1
v_sub_f32 v242, v242, v240
v_sub_f32 v243, v243, v240
v_cvt_pk_bf16_f32 v244, v242, v243
v_lshlrev_b32 v242, 16, v244
v_and_b32 v243, 0xffff0000, v244
v_mul_f32 v242, v242, v241
v_mul_f32 v243, v243, v241
v_cvt_pk_bf16_f32 v1, v242, v243
v_lshlrev_b32 v242, 16, v2
v_and_b32 v243, 0xffff0000, v2
v_sub_f32 v242, v242, v240
v_sub_f32 v243, v243, v240
v_cvt_pk_bf16_f32 v244, v242, v243
v_lshlrev_b32 v242, 16, v244
v_and_b32 v243, 0xffff0000, v244
v_mul_f32 v242, v242, v241
v_mul_f32 v243, v243, v241
v_cvt_pk_bf16_f32 v2, v242, v243
v_lshlrev_b32 v242, 16, v3
v_and_b32 v243, 0xffff0000, v3
v_sub_f32 v242, v242, v240
v_sub_f32 v243, v243, v240
v_cvt_pk_bf16_f32 v244, v242, v243
v_lshlrev_b32 v242, 16, v244
v_and_b32 v243, 0xffff0000, v244
v_mul_f32 v242, v242, v241
v_mul_f32 v243, v243, v241
v_cvt_pk_bf16_f32 v3, v242, v243
v_lshlrev_b32 v242, 16, v4
v_and_b32 v243, 0xffff0000, v4
v_sub_f32 v242, v242, v240
v_sub_f32 v243, v243, v240
v_cvt_pk_bf16_f32 v244, v242, v243
v_lshlrev_b32 v242, 16, v244
v_and_b32 v243, 0xffff0000, v244
v_mul_f32 v242, v242, v241
v_mul_f32 v243, v243, v241
v_cvt_pk_bf16_f32 v4, v242, v243
v_lshlrev_b32 v242, 16, v5
v_and_b32 v243, 0xffff0000, v5
v_sub_f32 v242, v242, v240
v_sub_f32 v243, v243, v240
v_cvt_pk_bf16_f32 v244, v242, v243
v_lshlrev_b32 v242, 16, v244
v_and_b32 v243, 0xffff0000, v244
v_mul_f32 v242, v242, v241
v_mul_f32 v243, v243, v241
v_cvt_pk_bf16_f32 v5, v242, v243
v_lshlrev_b32 v242, 16, v6
v_and_b32 v243, 0xffff0000, v6
v_sub_f32 v242, v242, v240
v_sub_f32 v243, v243, v240
v_cvt_pk_bf16_f32 v244, v242, v243
v_lshlrev_b32 v242, 16, v244
v_and_b32 v243, 0xffff0000, v244
v_mul_f32 v242, v242, v241
v_mul_f32 v243, v243, v241
v_cvt_pk_bf16_f32 v6, v242, v243
v_lshlrev_b32 v242, 16, v7
v_and_b32 v243, 0xffff0000, v7
v_sub_f32 v242, v242, v240
v_sub_f32 v243, v243, v240
v_cvt_pk_bf16_f32 v244, v242, v243
v_lshlrev_b32 v242, 16, v244
v_and_b32 v243, 0xffff0000, v244
v_mul_f32 v242, v242, v241
v_mul_f32 v243, v243, v241
v_cvt_pk_bf16_f32 v7, v242, v243
v_lshlrev_b32 v242, 16, v8
v_and_b32 v243, 0xffff0000, v8
v_sub_f32 v242, v242, v240
v_sub_f32 v243, v243, v240
v_cvt_pk_bf16_f32 v244, v242, v243
v_lshlrev_b32 v242, 16, v244
v_and_b32 v243, 0xffff0000, v244
v_mul_f32 v242, v242, v241
v_mul_f32 v243, v243, v241
v_cvt_pk_bf16_f32 v8, v242, v243
v_lshlrev_b32 v242, 16, v9
v_and_b32 v243, 0xffff0000, v9
v_sub_f32 v242, v242, v240
v_sub_f32 v243, v243, v240
v_cvt_pk_bf16_f32 v244, v242, v243
v_lshlrev_b32 v242, 16, v244
v_and_b32 v243, 0xffff0000, v244
v_mul_f32 v242, v242, v241
v_mul_f32 v243, v243, v241
v_cvt_pk_bf16_f32 v9, v242, v243
v_lshlrev_b32 v242, 16, v10
v_and_b32 v243, 0xffff0000, v10
v_sub_f32 v242, v242, v240
v_sub_f32 v243, v243, v240
v_cvt_pk_bf16_f32 v244, v242, v243
v_lshlrev_b32 v242, 16, v244
v_and_b32 v243, 0xffff0000, v244
v_mul_f32 v242, v242, v241
v_mul_f32 v243, v243, v241
v_cvt_pk_bf16_f32 v10, v242, v243
v_lshlrev_b32 v242, 16, v11
v_and_b32 v243, 0xffff0000, v11
v_sub_f32 v242, v242, v240
v_sub_f32 v243, v243, v240
v_cvt_pk_bf16_f32 v244, v242, v243
v_lshlrev_b32 v242, 16, v244
v_and_b32 v243, 0xffff0000, v244
v_mul_f32 v242, v242, v241
v_mul_f32 v243, v243, v241
v_cvt_pk_bf16_f32 v11, v242, v243
v_lshlrev_b32 v242, 16, v12
v_and_b32 v243, 0xffff0000, v12
v_sub_f32 v242, v242, v240
v_sub_f32 v243, v243, v240
v_cvt_pk_bf16_f32 v244, v242, v243
v_lshlrev_b32 v242, 16, v244
v_and_b32 v243, 0xffff0000, v244
v_mul_f32 v242, v242, v241
v_mul_f32 v243, v243, v241
v_cvt_pk_bf16_f32 v12, v242, v243
v_lshlrev_b32 v242, 16, v13
v_and_b32 v243, 0xffff0000, v13
v_sub_f32 v242, v242, v240
v_sub_f32 v243, v243, v240
v_cvt_pk_bf16_f32 v244, v242, v243
v_lshlrev_b32 v242, 16, v244
v_and_b32 v243, 0xffff0000, v244
v_mul_f32 v242, v242, v241
v_mul_f32 v243, v243, v241
v_cvt_pk_bf16_f32 v13, v242, v243
v_lshlrev_b32 v242, 16, v14
v_and_b32 v243, 0xffff0000, v14
v_sub_f32 v242, v242, v240
v_sub_f32 v243, v243, v240
v_cvt_pk_bf16_f32 v244, v242, v243
v_lshlrev_b32 v242, 16, v244
v_and_b32 v243, 0xffff0000, v244
v_mul_f32 v242, v242, v241
v_mul_f32 v243, v243, v241
v_cvt_pk_bf16_f32 v14, v242, v243
v_lshlrev_b32 v242, 16, v15
v_and_b32 v243, 0xffff0000, v15
v_sub_f32 v242, v242, v240
v_sub_f32 v243, v243, v240
v_cvt_pk_bf16_f32 v244, v242, v243
v_lshlrev_b32 v242, 16, v244
v_and_b32 v243, 0xffff0000, v244
v_mul_f32 v242, v242, v241
v_mul_f32 v243, v243, v241
v_cvt_pk_bf16_f32 v15, v242, v243
ds_write_b128 v237, v[0:3] offset:0
ds_write_b128 v237, v[4:7] offset:1024
ds_write_b128 v237, v[8:11] offset:2048
ds_write_b128 v237, v[12:15] offset:3072
s_add_u32 s9, s9, 4096
s_cmp_lt_u32 s9, 20480
s_cbranch_scc1 k1_kernel_axn
s_waitcnt lgkmcnt(0)
v_and_b32 v240, 1, v254
v_lshrrev_b32 v241, 2, v253
v_and_b32 v242, 3, v253
v_lshlrev_b32 v242, 3, v242
v_add_u32 v242, 81920, v242
v_mov_b32 v243, 0
v_lshl_add_u32 v243, v254, 3, v243
v_add_u32 v243, v243, v241
s_movk_i32 s9, 480
v_mad_u32_u24 v244, v243, s9, v242
v_mov_b32 v243, 4
v_lshl_add_u32 v243, v254, 3, v243
v_add_u32 v243, v243, v241
s_movk_i32 s9, 480
v_mad_u32_u24 v245, v243, s9, v242
s_mov_b32 s15, 0
s_mov_b32 s12, 0
k1_kernel_L:
s_waitcnt vmcnt(0)
s_barrier
s_add_u32 s8, s13, s14
s_add_u32 m0, s8, 0
s_nop 0
buffer_load_dwordx4 v192, s[48:51], s10 offen lds
s_add_u32 s8, s13, s14
s_add_u32 m0, s8, 1024
s_nop 0
buffer_load_dwordx4 v193, s[48:51], s10 offen lds
s_add_u32 s8, s13, s14
s_add_u32 m0, s8, 2048
s_nop 0
buffer_load_dwordx4 v194, s[48:51], s10 offen lds
s_add_u32 s8, s13, s14
s_add_u32 m0, s8, 3072
s_nop 0
buffer_load_dwordx4 v195, s[48:51], s10 offen lds
s_add_u32 s8, s13, s14
s_add_u32 m0, s8, 4096
s_nop 0
buffer_load_dwordx4 v196, s[48:51], s10 offen lds
s_add_u32 s8, s13, s14
s_add_u32 m0, s8, 5120
s_nop 0
buffer_load_dwordx4 v197, s[48:51], s10 offen lds
s_add_u32 s8, s13, s14
s_add_u32 m0, s8, 6144
s_nop 0
buffer_load_dwordx4 v198, s[48:51], s10 offen lds
s_add_u32 s8, s13, s14
s_add_u32 m0, s8, 7168
s_nop 0
buffer_load_dwordx4 v199, s[48:51], s10 offen lds
s_add_u32 s10, s10, 245760
s_add_u32 s14, s14, 32768
s_cmp_ge_u32 s14, 65536
s_cselect_b32 s14, 0, s14
v_add_u32 v246, s15, v244
v_add_u32 v247, s15, v245
v_add_u32 v237, s12, v236
ds_read_b128 v[32:35], v237 offset:0
ds_read_b128 v[36:39], v237 offset:1024
ds_read_b64_tr_b16 v[144:145], v246 offset:0
ds_read_b64_tr_b16 v[146:147], v247 offset:0
ds_read_b64_tr_b16 v[148:149], v246 offset:32
ds_read_b64_tr_b16 v[150:151], v247 offset:32
ds_read_b64_tr_b16 v[152:153], v246 offset:64
ds_read_b64_tr_b16 v[154:155], v247 offset:64
ds_read_b64_tr_b16 v[156:157], v246 offset:96
ds_read_b64_tr_b16 v[158:159], v247 offset:96
ds_read_b64_tr_b16 v[160:161], v246 offset:128
ds_read_b64_tr_b16 v[162:163], v247 offset:128
ds_read_b64_tr_b16 v[164:165], v246 offset:160
ds_read_b64_tr_b16 v[166:167], v247 offset:160
s_waitcnt lgkmcnt(10)
v_mfma_f32_16x16x32_bf16 a[0:3], v[144:147], v[32:35], a[0:3]
ds_read_b64_tr_b16 v[168:169], v246 offset:192
ds_read_b64_tr_b16 v[170:171], v247 offset:192
s_waitcnt lgkmcnt(10)
v_mfma_f32_16x16x32_bf16 a[4:7], v[148:151], v[32:35], a[4:7]
ds_read_b64_tr_b16 v[144:145], v246 offset:224
ds_read_b64_tr_b16 v[146:147], v247 offset:224
s_waitcnt lgkmcnt(10)
v_mfma_f32_16x16x32_bf16 a[8:11], v[152:155], v[32:35], a[8:11]
ds_read_b64_tr_b16 v[148:149], v246 offset:256
ds_read_b64_tr_b16 v[150:151], v247 offset:256
s_waitcnt lgkmcnt(10)
v_mfma_f32_16x16x32_bf16 a[12:15], v[156:159], v[32:35], a[12:15]
ds_read_b64_tr_b16 v[152:153], v246 offset:288
ds_read_b64_tr_b16 v[154:155], v247 offset:288
s_waitcnt lgkmcnt(10)
v_mfma_f32_16x16x32_bf16 a[16:19], v[160:163], v[32:35], a[16:19]
ds_read_b64_tr_b16 v[156:157], v246 offset:320
ds_read_b64_tr_b16 v[158:159], v247 offset:320
s_waitcnt lgkmcnt(10)
v_mfma_f32_16x16x32_bf16 a[20:23], v[164:167], v[32:35], a[20:23]
ds_read_b64_tr_b16 v[160:161], v246 offset:352
ds_read_b64_tr_b16 v[162:163], v247 offset:352
s_waitcnt lgkmcnt(10)
v_mfma_f32_16x16x32_bf16 a[24:27], v[168:171], v[32:35], a[24:27]
ds_read_b64_tr_b16 v[164:165], v246 offset:384
ds_read_b64_tr_b16 v[166:167], v247 offset:384
s_waitcnt lgkmcnt(10)
v_mfma_f32_16x16x32_bf16 a[28:31], v[144:147], v[32:35], a[28:31]
ds_read_b64_tr_b16 v[168:169], v246 offset:416
ds_read_b64_tr_b16 v[170:171], v247 offset:416
s_waitcnt lgkmcnt(10)
v_mfma_f32_16x16x32_bf16 a[32:35], v[148:151], v[32:35], a[32:35]
ds_read_b64_tr_b16 v[144:145], v246 offset:448
ds_read_b64_tr_b16 v[146:147], v247 offset:448
s_waitcnt lgkmcnt(10)
v_mfma_f32_16x16x32_bf16 a[36:39], v[152:155], v[32:35], a[36:39]
ds_read_b64_tr_b16 v[148:149], v246 offset:15360
ds_read_b64_tr_b16 v[150:151], v247 offset:15360
s_waitcnt lgkmcnt(10)
v_mfma_f32_16x16x32_bf16 a[40:43], v[156:159], v[32:35], a[40:43]
ds_read_b64_tr_b16 v[152:153], v246 offset:15392
ds_read_b64_tr_b16 v[154:155], v247 offset:15392
s_waitcnt lgkmcnt(10)
v_mfma_f32_16x16x32_bf16 a[44:47], v[160:163], v[32:35], a[44:47]
ds_read_b64_tr_b16 v[156:157], v246 offset:15424
ds_read_b64_tr_b16 v[158:159], v247 offset:15424
s_waitcnt lgkmcnt(10)
v_mfma_f32_16x16x32_bf16 a[48:51], v[164:167], v[32:35], a[48:51]
ds_read_b64_tr_b16 v[160:161], v246 offset:15456
ds_read_b64_tr_b16 v[162:163], v247 offset:15456
s_waitcnt lgkmcnt(10)
v_mfma_f32_16x16x32_bf16 a[52:55], v[168:171], v[32:35], a[52:55]
ds_read_b64_tr_b16 v[164:165], v246 offset:15488
ds_read_b64_tr_b16 v[166:167], v247 offset:15488
s_waitcnt lgkmcnt(10)
v_mfma_f32_16x16x32_bf16 a[56:59], v[144:147], v[32:35], a[56:59]
ds_read_b64_tr_b16 v[168:169], v246 offset:15520
ds_read_b64_tr_b16 v[170:171], v247 offset:15520
s_waitcnt lgkmcnt(10)
v_mfma_f32_16x16x32_bf16 a[0:3], v[148:151], v[36:39], a[0:3]
ds_read_b64_tr_b16 v[144:145], v246 offset:15552
ds_read_b64_tr_b16 v[146:147], v247 offset:15552
s_waitcnt lgkmcnt(10)
v_mfma_f32_16x16x32_bf16 a[4:7], v[152:155], v[36:39], a[4:7]
ds_read_b64_tr_b16 v[148:149], v246 offset:15584
ds_read_b64_tr_b16 v[150:151], v247 offset:15584
s_waitcnt lgkmcnt(10)
v_mfma_f32_16x16x32_bf16 a[8:11], v[156:159], v[36:39], a[8:11]
ds_read_b64_tr_b16 v[152:153], v246 offset:15616
ds_read_b64_tr_b16 v[154:155], v247 offset:15616
s_waitcnt lgkmcnt(10)
v_mfma_f32_16x16x32_bf16 a[12:15], v[160:163], v[36:39], a[12:15]
ds_read_b64_tr_b16 v[156:157], v246 offset:15648
ds_read_b64_tr_b16 v[158:159], v247 offset:15648
s_waitcnt lgkmcnt(10)
v_mfma_f32_16x16x32_bf16 a[16:19], v[164:167], v[36:39], a[16:19]
ds_read_b64_tr_b16 v[160:161], v246 offset:15680
ds_read_b64_tr_b16 v[162:163], v247 offset:15680
s_waitcnt lgkmcnt(10)
v_mfma_f32_16x16x32_bf16 a[20:23], v[168:171], v[36:39], a[20:23]
ds_read_b64_tr_b16 v[164:165], v246 offset:15712
ds_read_b64_tr_b16 v[166:167], v247 offset:15712
s_waitcnt lgkmcnt(10)
v_mfma_f32_16x16x32_bf16 a[24:27], v[144:147], v[36:39], a[24:27]
ds_read_b64_tr_b16 v[168:169], v246 offset:15744
ds_read_b64_tr_b16 v[170:171], v247 offset:15744
s_waitcnt lgkmcnt(10)
v_mfma_f32_16x16x32_bf16 a[28:31], v[148:151], v[36:39], a[28:31]
ds_read_b64_tr_b16 v[144:145], v246 offset:15776
ds_read_b64_tr_b16 v[146:147], v247 offset:15776
s_waitcnt lgkmcnt(10)
v_mfma_f32_16x16x32_bf16 a[32:35], v[152:155], v[36:39], a[32:35]
ds_read_b64_tr_b16 v[148:149], v246 offset:15808
ds_read_b64_tr_b16 v[150:151], v247 offset:15808
s_waitcnt lgkmcnt(10)
v_mfma_f32_16x16x32_bf16 a[36:39], v[156:159], v[36:39], a[36:39]
s_waitcnt lgkmcnt(8)
v_mfma_f32_16x16x32_bf16 a[40:43], v[160:163], v[36:39], a[40:43]
s_waitcnt lgkmcnt(6)
v_mfma_f32_16x16x32_bf16 a[44:47], v[164:167], v[36:39], a[44:47]
s_waitcnt lgkmcnt(4)
v_mfma_f32_16x16x32_bf16 a[48:51], v[168:171], v[36:39], a[48:51]
s_waitcnt lgkmcnt(2)
v_mfma_f32_16x16x32_bf16 a[52:55], v[144:147], v[36:39], a[52:55]
s_waitcnt lgkmcnt(0)
v_mfma_f32_16x16x32_bf16 a[56:59], v[148:151], v[36:39], a[56:59]
s_add_u32 s15, s15, 32768
s_cmp_ge_u32 s15, 65536
s_cselect_b32 s15, 0, s15
s_add_u32 s12, s12, 2048
s_cmp_lt_u32 s12, 20480
s_cbranch_scc1 k1_kernel_L
s_waitcnt vmcnt(0)
s_nop 7
s_nop 7
s_mov_b32 s52, s36
s_mov_b32 s53, s37
s_mov_b32 s54, 2621440
s_mov_b32 s55, 0x00020000
s_mul_i32 s10, s5, 160
v_lshlrev_b32 v241, 3, v254
v_add_u32 v242, s10, v241
s_movk_i32 s9, 1280
v_mad_u32_u24 v240, v255, s9, v242
v_lshl_add_u32 v243, s3, 4, v253
s_movk_i32 s9, 320
v_mad_u32_u24 v243, v243, s9, v241
s_barrier
v_accvgpr_read_b32 v224, a0
v_cvt_pk_bf16_f32 v224, v224, v224
v_and_b32 v224, 0xffff0000, v224
v_mul_f32 v232, 0x3fb8aa3b, v224
v_exp_f32 v232, v232
v_add_f32 v233, 1.0, v224
v_cmp_lt_f32 vcc, 0, v224
s_nop 1
v_cndmask_b32 v224, v232, v233, vcc
v_cvt_pk_bf16_f32 v224, v224, v224
v_and_b32 v224, 0xffff0000, v224
v_add_f32 v224, 0x358637bd, v224
v_accvgpr_read_b32 v225, a1
v_cvt_pk_bf16_f32 v225, v225, v225
v_and_b32 v225, 0xffff0000, v225
v_mul_f32 v232, 0x3fb8aa3b, v225
v_exp_f32 v232, v232
v_add_f32 v233, 1.0, v225
v_cmp_lt_f32 vcc, 0, v225
s_nop 1
v_cndmask_b32 v225, v232, v233, vcc
v_cvt_pk_bf16_f32 v225, v225, v225
v_and_b32 v225, 0xffff0000, v225
v_add_f32 v225, 0x358637bd, v225
v_accvgpr_read_b32 v226, a2
v_cvt_pk_bf16_f32 v226, v226, v226
v_and_b32 v226, 0xffff0000, v226
v_mul_f32 v232, 0x3fb8aa3b, v226
v_exp_f32 v232, v232
v_add_f32 v233, 1.0, v226
v_cmp_lt_f32 vcc, 0, v226
s_nop 1
v_cndmask_b32 v226, v232, v233, vcc
v_cvt_pk_bf16_f32 v226, v226, v226
v_and_b32 v226, 0xffff0000, v226
v_add_f32 v226, 0x358637bd, v226
v_accvgpr_read_b32 v227, a3
v_cvt_pk_bf16_f32 v227, v227, v227
v_and_b32 v227, 0xffff0000, v227
v_mul_f32 v232, 0x3fb8aa3b, v227
v_exp_f32 v232, v232
v_add_f32 v233, 1.0, v227
v_cmp_lt_f32 vcc, 0, v227
s_nop 1
v_cndmask_b32 v227, v232, v233, vcc
v_cvt_pk_bf16_f32 v227, v227, v227
v_and_b32 v227, 0xffff0000, v227
v_add_f32 v227, 0x358637bd, v227
v_cvt_pk_bf16_f32 v224, v224, v225
v_cvt_pk_bf16_f32 v225, v226, v227
buffer_store_dwordx2 v[224:225], v240, s[52:55], 0 offen offset:0
v_accvgpr_read_b32 v224, a4
v_cvt_pk_bf16_f32 v224, v224, v224
v_and_b32 v224, 0xffff0000, v224
v_mul_f32 v232, 0x3fb8aa3b, v224
v_exp_f32 v232, v232
v_add_f32 v233, 1.0, v224
v_cmp_lt_f32 vcc, 0, v224
s_nop 1
v_cndmask_b32 v224, v232, v233, vcc
v_cvt_pk_bf16_f32 v224, v224, v224
v_and_b32 v224, 0xffff0000, v224
v_add_f32 v224, 0x358637bd, v224
v_accvgpr_read_b32 v225, a5
v_cvt_pk_bf16_f32 v225, v225, v225
v_and_b32 v225, 0xffff0000, v225
v_mul_f32 v232, 0x3fb8aa3b, v225
v_exp_f32 v232, v232
v_add_f32 v233, 1.0, v225
v_cmp_lt_f32 vcc, 0, v225
s_nop 1
v_cndmask_b32 v225, v232, v233, vcc
v_cvt_pk_bf16_f32 v225, v225, v225
v_and_b32 v225, 0xffff0000, v225
v_add_f32 v225, 0x358637bd, v225
v_accvgpr_read_b32 v226, a6
v_cvt_pk_bf16_f32 v226, v226, v226
v_and_b32 v226, 0xffff0000, v226
v_mul_f32 v232, 0x3fb8aa3b, v226
v_exp_f32 v232, v232
v_add_f32 v233, 1.0, v226
v_cmp_lt_f32 vcc, 0, v226
s_nop 1
v_cndmask_b32 v226, v232, v233, vcc
v_cvt_pk_bf16_f32 v226, v226, v226
v_and_b32 v226, 0xffff0000, v226
v_add_f32 v226, 0x358637bd, v226
v_accvgpr_read_b32 v227, a7
v_cvt_pk_bf16_f32 v227, v227, v227
v_and_b32 v227, 0xffff0000, v227
v_mul_f32 v232, 0x3fb8aa3b, v227
v_exp_f32 v232, v232
v_add_f32 v233, 1.0, v227
v_cmp_lt_f32 vcc, 0, v227
s_nop 1
v_cndmask_b32 v227, v232, v233, vcc
v_cvt_pk_bf16_f32 v227, v227, v227
v_and_b32 v227, 0xffff0000, v227
v_add_f32 v227, 0x358637bd, v227
v_cvt_pk_bf16_f32 v224, v224, v225
v_cvt_pk_bf16_f32 v225, v226, v227
buffer_store_dwordx2 v[224:225], v240, s[52:55], 0 offen offset:32
v_accvgpr_read_b32 v224, a8
v_cvt_pk_bf16_f32 v224, v224, v224
v_and_b32 v224, 0xffff0000, v224
v_mul_f32 v232, 0x3fb8aa3b, v224
v_exp_f32 v232, v232
v_add_f32 v233, 1.0, v224
v_cmp_lt_f32 vcc, 0, v224
s_nop 1
v_cndmask_b32 v224, v232, v233, vcc
v_cvt_pk_bf16_f32 v224, v224, v224
v_and_b32 v224, 0xffff0000, v224
v_add_f32 v224, 0x358637bd, v224
v_accvgpr_read_b32 v225, a9
v_cvt_pk_bf16_f32 v225, v225, v225
v_and_b32 v225, 0xffff0000, v225
v_mul_f32 v232, 0x3fb8aa3b, v225
v_exp_f32 v232, v232
v_add_f32 v233, 1.0, v225
v_cmp_lt_f32 vcc, 0, v225
s_nop 1
v_cndmask_b32 v225, v232, v233, vcc
v_cvt_pk_bf16_f32 v225, v225, v225
v_and_b32 v225, 0xffff0000, v225
v_add_f32 v225, 0x358637bd, v225
v_accvgpr_read_b32 v226, a10
v_cvt_pk_bf16_f32 v226, v226, v226
v_and_b32 v226, 0xffff0000, v226
v_mul_f32 v232, 0x3fb8aa3b, v226
v_exp_f32 v232, v232
v_add_f32 v233, 1.0, v226
v_cmp_lt_f32 vcc, 0, v226
s_nop 1
v_cndmask_b32 v226, v232, v233, vcc
v_cvt_pk_bf16_f32 v226, v226, v226
v_and_b32 v226, 0xffff0000, v226
v_add_f32 v226, 0x358637bd, v226
v_accvgpr_read_b32 v227, a11
v_cvt_pk_bf16_f32 v227, v227, v227
v_and_b32 v227, 0xffff0000, v227
v_mul_f32 v232, 0x3fb8aa3b, v227
v_exp_f32 v232, v232
v_add_f32 v233, 1.0, v227
v_cmp_lt_f32 vcc, 0, v227
s_nop 1
v_cndmask_b32 v227, v232, v233, vcc
v_cvt_pk_bf16_f32 v227, v227, v227
v_and_b32 v227, 0xffff0000, v227
v_add_f32 v227, 0x358637bd, v227
v_cvt_pk_bf16_f32 v224, v224, v225
v_cvt_pk_bf16_f32 v225, v226, v227
buffer_store_dwordx2 v[224:225], v240, s[52:55], 0 offen offset:64
v_accvgpr_read_b32 v224, a12
v_cvt_pk_bf16_f32 v224, v224, v224
v_and_b32 v224, 0xffff0000, v224
v_mul_f32 v232, 0x3fb8aa3b, v224
v_exp_f32 v232, v232
v_add_f32 v233, 1.0, v224
v_cmp_lt_f32 vcc, 0, v224
s_nop 1
v_cndmask_b32 v224, v232, v233, vcc
v_cvt_pk_bf16_f32 v224, v224, v224
v_and_b32 v224, 0xffff0000, v224
v_add_f32 v224, 0x358637bd, v224
v_accvgpr_read_b32 v225, a13
v_cvt_pk_bf16_f32 v225, v225, v225
v_and_b32 v225, 0xffff0000, v225
v_mul_f32 v232, 0x3fb8aa3b, v225
v_exp_f32 v232, v232
v_add_f32 v233, 1.0, v225
v_cmp_lt_f32 vcc, 0, v225
s_nop 1
v_cndmask_b32 v225, v232, v233, vcc
v_cvt_pk_bf16_f32 v225, v225, v225
v_and_b32 v225, 0xffff0000, v225
v_add_f32 v225, 0x358637bd, v225
v_accvgpr_read_b32 v226, a14
v_cvt_pk_bf16_f32 v226, v226, v226
v_and_b32 v226, 0xffff0000, v226
v_mul_f32 v232, 0x3fb8aa3b, v226
v_exp_f32 v232, v232
v_add_f32 v233, 1.0, v226
v_cmp_lt_f32 vcc, 0, v226
s_nop 1
v_cndmask_b32 v226, v232, v233, vcc
v_cvt_pk_bf16_f32 v226, v226, v226
v_and_b32 v226, 0xffff0000, v226
v_add_f32 v226, 0x358637bd, v226
v_accvgpr_read_b32 v227, a15
v_cvt_pk_bf16_f32 v227, v227, v227
v_and_b32 v227, 0xffff0000, v227
v_mul_f32 v232, 0x3fb8aa3b, v227
v_exp_f32 v232, v232
v_add_f32 v233, 1.0, v227
v_cmp_lt_f32 vcc, 0, v227
s_nop 1
v_cndmask_b32 v227, v232, v233, vcc
v_cvt_pk_bf16_f32 v227, v227, v227
v_and_b32 v227, 0xffff0000, v227
v_add_f32 v227, 0x358637bd, v227
v_cvt_pk_bf16_f32 v224, v224, v225
v_cvt_pk_bf16_f32 v225, v226, v227
buffer_store_dwordx2 v[224:225], v240, s[52:55], 0 offen offset:96
v_accvgpr_read_b32 v224, a16
v_cvt_pk_bf16_f32 v224, v224, v224
v_and_b32 v224, 0xffff0000, v224
v_mul_f32 v232, 0x3fb8aa3b, v224
v_exp_f32 v232, v232
v_add_f32 v233, 1.0, v224
v_cmp_lt_f32 vcc, 0, v224
s_nop 1
v_cndmask_b32 v224, v232, v233, vcc
v_cvt_pk_bf16_f32 v224, v224, v224
v_and_b32 v224, 0xffff0000, v224
v_add_f32 v224, 0x358637bd, v224
v_accvgpr_read_b32 v225, a17
v_cvt_pk_bf16_f32 v225, v225, v225
v_and_b32 v225, 0xffff0000, v225
v_mul_f32 v232, 0x3fb8aa3b, v225
v_exp_f32 v232, v232
v_add_f32 v233, 1.0, v225
v_cmp_lt_f32 vcc, 0, v225
s_nop 1
v_cndmask_b32 v225, v232, v233, vcc
v_cvt_pk_bf16_f32 v225, v225, v225
v_and_b32 v225, 0xffff0000, v225
v_add_f32 v225, 0x358637bd, v225
v_accvgpr_read_b32 v226, a18
v_cvt_pk_bf16_f32 v226, v226, v226
v_and_b32 v226, 0xffff0000, v226
v_mul_f32 v232, 0x3fb8aa3b, v226
v_exp_f32 v232, v232
v_add_f32 v233, 1.0, v226
v_cmp_lt_f32 vcc, 0, v226
s_nop 1
v_cndmask_b32 v226, v232, v233, vcc
v_cvt_pk_bf16_f32 v226, v226, v226
v_and_b32 v226, 0xffff0000, v226
v_add_f32 v226, 0x358637bd, v226
v_accvgpr_read_b32 v227, a19
v_cvt_pk_bf16_f32 v227, v227, v227
v_and_b32 v227, 0xffff0000, v227
v_mul_f32 v232, 0x3fb8aa3b, v227
v_exp_f32 v232, v232
v_add_f32 v233, 1.0, v227
v_cmp_lt_f32 vcc, 0, v227
s_nop 1
v_cndmask_b32 v227, v232, v233, vcc
v_cvt_pk_bf16_f32 v227, v227, v227
v_and_b32 v227, 0xffff0000, v227
v_add_f32 v227, 0x358637bd, v227
v_cvt_pk_bf16_f32 v224, v224, v225
v_cvt_pk_bf16_f32 v225, v226, v227
buffer_store_dwordx2 v[224:225], v240, s[52:55], 0 offen offset:128
v_accvgpr_read_b32 v224, a20
v_cvt_pk_bf16_f32 v224, v224, v224
v_and_b32 v224, 0xffff0000, v224
v_mul_f32 v232, 0x3fb8aa3b, v224
v_exp_f32 v232, v232
v_add_f32 v233, 1.0, v224
v_cmp_lt_f32 vcc, 0, v224
s_nop 1
v_cndmask_b32 v224, v232, v233, vcc
v_cvt_pk_bf16_f32 v224, v224, v224
v_and_b32 v224, 0xffff0000, v224
v_add_f32 v224, 0x358637bd, v224
v_accvgpr_read_b32 v225, a21
v_cvt_pk_bf16_f32 v225, v225, v225
v_and_b32 v225, 0xffff0000, v225
v_mul_f32 v232, 0x3fb8aa3b, v225
v_exp_f32 v232, v232
v_add_f32 v233, 1.0, v225
v_cmp_lt_f32 vcc, 0, v225
s_nop 1
v_cndmask_b32 v225, v232, v233, vcc
v_cvt_pk_bf16_f32 v225, v225, v225
v_and_b32 v225, 0xffff0000, v225
v_add_f32 v225, 0x358637bd, v225
v_accvgpr_read_b32 v226, a22
v_cvt_pk_bf16_f32 v226, v226, v226
v_and_b32 v226, 0xffff0000, v226
v_mul_f32 v232, 0x3fb8aa3b, v226
v_exp_f32 v232, v232
v_add_f32 v233, 1.0, v226
v_cmp_lt_f32 vcc, 0, v226
s_nop 1
v_cndmask_b32 v226, v232, v233, vcc
v_cvt_pk_bf16_f32 v226, v226, v226
v_and_b32 v226, 0xffff0000, v226
v_add_f32 v226, 0x358637bd, v226
v_accvgpr_read_b32 v227, a23
v_cvt_pk_bf16_f32 v227, v227, v227
v_and_b32 v227, 0xffff0000, v227
v_mul_f32 v232, 0x3fb8aa3b, v227
v_exp_f32 v232, v232
v_add_f32 v233, 1.0, v227
v_cmp_lt_f32 vcc, 0, v227
s_nop 1
v_cndmask_b32 v227, v232, v233, vcc
v_cvt_pk_bf16_f32 v227, v227, v227
v_and_b32 v227, 0xffff0000, v227
v_add_f32 v227, 0x358637bd, v227
v_cvt_pk_bf16_f32 v224, v224, v225
v_cvt_pk_bf16_f32 v225, v226, v227
ds_write_b64 v243, v[224:225] offset:0
v_accvgpr_read_b32 v224, a24
v_cvt_pk_bf16_f32 v224, v224, v224
v_and_b32 v224, 0xffff0000, v224
v_mul_f32 v232, 0x3fb8aa3b, v224
v_exp_f32 v232, v232
v_add_f32 v233, 1.0, v224
v_cmp_lt_f32 vcc, 0, v224
s_nop 1
v_cndmask_b32 v224, v232, v233, vcc
v_cvt_pk_bf16_f32 v224, v224, v224
v_and_b32 v224, 0xffff0000, v224
v_add_f32 v224, 0x358637bd, v224
v_accvgpr_read_b32 v225, a25
v_cvt_pk_bf16_f32 v225, v225, v225
v_and_b32 v225, 0xffff0000, v225
v_mul_f32 v232, 0x3fb8aa3b, v225
v_exp_f32 v232, v232
v_add_f32 v233, 1.0, v225
v_cmp_lt_f32 vcc, 0, v225
s_nop 1
v_cndmask_b32 v225, v232, v233, vcc
v_cvt_pk_bf16_f32 v225, v225, v225
v_and_b32 v225, 0xffff0000, v225
v_add_f32 v225, 0x358637bd, v225
v_accvgpr_read_b32 v226, a26
v_cvt_pk_bf16_f32 v226, v226, v226
v_and_b32 v226, 0xffff0000, v226
v_mul_f32 v232, 0x3fb8aa3b, v226
v_exp_f32 v232, v232
v_add_f32 v233, 1.0, v226
v_cmp_lt_f32 vcc, 0, v226
s_nop 1
v_cndmask_b32 v226, v232, v233, vcc
v_cvt_pk_bf16_f32 v226, v226, v226
v_and_b32 v226, 0xffff0000, v226
v_add_f32 v226, 0x358637bd, v226
v_accvgpr_read_b32 v227, a27
v_cvt_pk_bf16_f32 v227, v227, v227
v_and_b32 v227, 0xffff0000, v227
v_mul_f32 v232, 0x3fb8aa3b, v227
v_exp_f32 v232, v232
v_add_f32 v233, 1.0, v227
v_cmp_lt_f32 vcc, 0, v227
s_nop 1
v_cndmask_b32 v227, v232, v233, vcc
v_cvt_pk_bf16_f32 v227, v227, v227
v_and_b32 v227, 0xffff0000, v227
v_add_f32 v227, 0x358637bd, v227
v_cvt_pk_bf16_f32 v224, v224, v225
v_cvt_pk_bf16_f32 v225, v226, v227
ds_write_b64 v243, v[224:225] offset:32
v_accvgpr_read_b32 v224, a28
v_cvt_pk_bf16_f32 v224, v224, v224
v_and_b32 v224, 0xffff0000, v224
v_mul_f32 v232, 0x3fb8aa3b, v224
v_exp_f32 v232, v232
v_add_f32 v233, 1.0, v224
v_cmp_lt_f32 vcc, 0, v224
s_nop 1
v_cndmask_b32 v224, v232, v233, vcc
v_cvt_pk_bf16_f32 v224, v224, v224
v_and_b32 v224, 0xffff0000, v224
v_add_f32 v224, 0x358637bd, v224
v_accvgpr_read_b32 v225, a29
v_cvt_pk_bf16_f32 v225, v225, v225
v_and_b32 v225, 0xffff0000, v225
v_mul_f32 v232, 0x3fb8aa3b, v225
v_exp_f32 v232, v232
v_add_f32 v233, 1.0, v225
v_cmp_lt_f32 vcc, 0, v225
s_nop 1
v_cndmask_b32 v225, v232, v233, vcc
v_cvt_pk_bf16_f32 v225, v225, v225
v_and_b32 v225, 0xffff0000, v225
v_add_f32 v225, 0x358637bd, v225
v_accvgpr_read_b32 v226, a30
v_cvt_pk_bf16_f32 v226, v226, v226
v_and_b32 v226, 0xffff0000, v226
v_mul_f32 v232, 0x3fb8aa3b, v226
v_exp_f32 v232, v232
v_add_f32 v233, 1.0, v226
v_cmp_lt_f32 vcc, 0, v226
s_nop 1
v_cndmask_b32 v226, v232, v233, vcc
v_cvt_pk_bf16_f32 v226, v226, v226
v_and_b32 v226, 0xffff0000, v226
v_add_f32 v226, 0x358637bd, v226
v_accvgpr_read_b32 v227, a31
v_cvt_pk_bf16_f32 v227, v227, v227
v_and_b32 v227, 0xffff0000, v227
v_mul_f32 v232, 0x3fb8aa3b, v227
v_exp_f32 v232, v232
v_add_f32 v233, 1.0, v227
v_cmp_lt_f32 vcc, 0, v227
s_nop 1
v_cndmask_b32 v227, v232, v233, vcc
v_cvt_pk_bf16_f32 v227, v227, v227
v_and_b32 v227, 0xffff0000, v227
v_add_f32 v227, 0x358637bd, v227
v_cvt_pk_bf16_f32 v224, v224, v225
v_cvt_pk_bf16_f32 v225, v226, v227
ds_write_b64 v243, v[224:225] offset:64
v_accvgpr_read_b32 v224, a32
v_cvt_pk_bf16_f32 v224, v224, v224
v_and_b32 v224, 0xffff0000, v224
v_mul_f32 v232, 0x3fb8aa3b, v224
v_exp_f32 v232, v232
v_add_f32 v233, 1.0, v224
v_cmp_lt_f32 vcc, 0, v224
s_nop 1
v_cndmask_b32 v224, v232, v233, vcc
v_cvt_pk_bf16_f32 v224, v224, v224
v_and_b32 v224, 0xffff0000, v224
v_add_f32 v224, 0x358637bd, v224
v_accvgpr_read_b32 v225, a33
v_cvt_pk_bf16_f32 v225, v225, v225
v_and_b32 v225, 0xffff0000, v225
v_mul_f32 v232, 0x3fb8aa3b, v225
v_exp_f32 v232, v232
v_add_f32 v233, 1.0, v225
v_cmp_lt_f32 vcc, 0, v225
s_nop 1
v_cndmask_b32 v225, v232, v233, vcc
v_cvt_pk_bf16_f32 v225, v225, v225
v_and_b32 v225, 0xffff0000, v225
v_add_f32 v225, 0x358637bd, v225
v_accvgpr_read_b32 v226, a34
v_cvt_pk_bf16_f32 v226, v226, v226
v_and_b32 v226, 0xffff0000, v226
v_mul_f32 v232, 0x3fb8aa3b, v226
v_exp_f32 v232, v232
v_add_f32 v233, 1.0, v226
v_cmp_lt_f32 vcc, 0, v226
s_nop 1
v_cndmask_b32 v226, v232, v233, vcc
v_cvt_pk_bf16_f32 v226, v226, v226
v_and_b32 v226, 0xffff0000, v226
v_add_f32 v226, 0x358637bd, v226
v_accvgpr_read_b32 v227, a35
v_cvt_pk_bf16_f32 v227, v227, v227
v_and_b32 v227, 0xffff0000, v227
v_mul_f32 v232, 0x3fb8aa3b, v227
v_exp_f32 v232, v232
v_add_f32 v233, 1.0, v227
v_cmp_lt_f32 vcc, 0, v227
s_nop 1
v_cndmask_b32 v227, v232, v233, vcc
v_cvt_pk_bf16_f32 v227, v227, v227
v_and_b32 v227, 0xffff0000, v227
v_add_f32 v227, 0x358637bd, v227
v_cvt_pk_bf16_f32 v224, v224, v225
v_cvt_pk_bf16_f32 v225, v226, v227
ds_write_b64 v243, v[224:225] offset:96
v_accvgpr_read_b32 v224, a36
v_cvt_pk_bf16_f32 v224, v224, v224
v_and_b32 v224, 0xffff0000, v224
v_mul_f32 v232, 0x3fb8aa3b, v224
v_exp_f32 v232, v232
v_add_f32 v233, 1.0, v224
v_cmp_lt_f32 vcc, 0, v224
s_nop 1
v_cndmask_b32 v224, v232, v233, vcc
v_cvt_pk_bf16_f32 v224, v224, v224
v_and_b32 v224, 0xffff0000, v224
v_add_f32 v224, 0x358637bd, v224
v_accvgpr_read_b32 v225, a37
v_cvt_pk_bf16_f32 v225, v225, v225
v_and_b32 v225, 0xffff0000, v225
v_mul_f32 v232, 0x3fb8aa3b, v225
v_exp_f32 v232, v232
v_add_f32 v233, 1.0, v225
v_cmp_lt_f32 vcc, 0, v225
s_nop 1
v_cndmask_b32 v225, v232, v233, vcc
v_cvt_pk_bf16_f32 v225, v225, v225
v_and_b32 v225, 0xffff0000, v225
v_add_f32 v225, 0x358637bd, v225
v_accvgpr_read_b32 v226, a38
v_cvt_pk_bf16_f32 v226, v226, v226
v_and_b32 v226, 0xffff0000, v226
v_mul_f32 v232, 0x3fb8aa3b, v226
v_exp_f32 v232, v232
v_add_f32 v233, 1.0, v226
v_cmp_lt_f32 vcc, 0, v226
s_nop 1
v_cndmask_b32 v226, v232, v233, vcc
v_cvt_pk_bf16_f32 v226, v226, v226
v_and_b32 v226, 0xffff0000, v226
v_add_f32 v226, 0x358637bd, v226
v_accvgpr_read_b32 v227, a39
v_cvt_pk_bf16_f32 v227, v227, v227
v_and_b32 v227, 0xffff0000, v227
v_mul_f32 v232, 0x3fb8aa3b, v227
v_exp_f32 v232, v232
v_add_f32 v233, 1.0, v227
v_cmp_lt_f32 vcc, 0, v227
s_nop 1
v_cndmask_b32 v227, v232, v233, vcc
v_cvt_pk_bf16_f32 v227, v227, v227
v_and_b32 v227, 0xffff0000, v227
v_add_f32 v227, 0x358637bd, v227
v_cvt_pk_bf16_f32 v224, v224, v225
v_cvt_pk_bf16_f32 v225, v226, v227
ds_write_b64 v243, v[224:225] offset:128
v_accvgpr_read_b32 v224, a40
v_cvt_pk_bf16_f32 v224, v224, v224
v_and_b32 v224, 0xffff0000, v224
v_accvgpr_read_b32 v225, a41
v_cvt_pk_bf16_f32 v225, v225, v225
v_and_b32 v225, 0xffff0000, v225
v_accvgpr_read_b32 v226, a42
v_cvt_pk_bf16_f32 v226, v226, v226
v_and_b32 v226, 0xffff0000, v226
v_accvgpr_read_b32 v227, a43
v_cvt_pk_bf16_f32 v227, v227, v227
v_and_b32 v227, 0xffff0000, v227
v_cvt_pk_bf16_f32 v224, v224, v225
v_cvt_pk_bf16_f32 v225, v226, v227
ds_write_b64 v243, v[224:225] offset:160
v_accvgpr_read_b32 v224, a44
v_cvt_pk_bf16_f32 v224, v224, v224
v_and_b32 v224, 0xffff0000, v224
v_accvgpr_read_b32 v225, a45
v_cvt_pk_bf16_f32 v225, v225, v225
v_and_b32 v225, 0xffff0000, v225
v_accvgpr_read_b32 v226, a46
v_cvt_pk_bf16_f32 v226, v226, v226
v_and_b32 v226, 0xffff0000, v226
v_accvgpr_read_b32 v227, a47
v_cvt_pk_bf16_f32 v227, v227, v227
v_and_b32 v227, 0xffff0000, v227
v_cvt_pk_bf16_f32 v224, v224, v225
v_cvt_pk_bf16_f32 v225, v226, v227
ds_write_b64 v243, v[224:225] offset:192
v_accvgpr_read_b32 v224, a48
v_cvt_pk_bf16_f32 v224, v224, v224
v_and_b32 v224, 0xffff0000, v224
v_accvgpr_read_b32 v225, a49
v_cvt_pk_bf16_f32 v225, v225, v225
v_and_b32 v225, 0xffff0000, v225
v_accvgpr_read_b32 v226, a50
v_cvt_pk_bf16_f32 v226, v226, v226
v_and_b32 v226, 0xffff0000, v226
v_accvgpr_read_b32 v227, a51
v_cvt_pk_bf16_f32 v227, v227, v227
v_and_b32 v227, 0xffff0000, v227
v_cvt_pk_bf16_f32 v224, v224, v225
v_cvt_pk_bf16_f32 v225, v226, v227
ds_write_b64 v243, v[224:225] offset:224
v_accvgpr_read_b32 v224, a52
v_cvt_pk_bf16_f32 v224, v224, v224
v_and_b32 v224, 0xffff0000, v224
v_accvgpr_read_b32 v225, a53
v_cvt_pk_bf16_f32 v225, v225, v225
v_and_b32 v225, 0xffff0000, v225
v_accvgpr_read_b32 v226, a54
v_cvt_pk_bf16_f32 v226, v226, v226
v_and_b32 v226, 0xffff0000, v226
v_accvgpr_read_b32 v227, a55
v_cvt_pk_bf16_f32 v227, v227, v227
v_and_b32 v227, 0xffff0000, v227
v_cvt_pk_bf16_f32 v224, v224, v225
v_cvt_pk_bf16_f32 v225, v226, v227
ds_write_b64 v243, v[224:225] offset:256
v_accvgpr_read_b32 v224, a56
v_cvt_pk_bf16_f32 v224, v224, v224
v_and_b32 v224, 0xffff0000, v224
v_accvgpr_read_b32 v225, a57
v_cvt_pk_bf16_f32 v225, v225, v225
v_and_b32 v225, 0xffff0000, v225
v_accvgpr_read_b32 v226, a58
v_cvt_pk_bf16_f32 v226, v226, v226
v_and_b32 v226, 0xffff0000, v226
v_accvgpr_read_b32 v227, a59
v_cvt_pk_bf16_f32 v227, v227, v227
v_and_b32 v227, 0xffff0000, v227
v_cvt_pk_bf16_f32 v224, v224, v225
v_cvt_pk_bf16_f32 v225, v226, v227
ds_write_b64 v243, v[224:225] offset:288
s_waitcnt vmcnt(0) lgkmcnt(0)
s_barrier
v_lshrrev_b32 v241, 2, v253
v_and_b32 v242, 3, v253
v_lshlrev_b32 v242, 3, v242
s_mul_i32 s10, s3, 40
v_add_u32 v242, s10, v242
v_lshl_add_u32 v243, v254, 3, v241
v_add_u32 v243, 0, v243
s_movk_i32 s9, 320
v_mad_u32_u24 v244, v243, s9, v242
v_lshl_add_u32 v243, v254, 3, v241
v_add_u32 v243, 4, v243
s_movk_i32 s9, 320
v_mad_u32_u24 v245, v243, s9, v242
v_mov_b32 v0, 0
v_mov_b32 v1, 0
v_mov_b32 v2, 0
v_mov_b32 v3, 0
v_mov_b32 v4, 0
v_mov_b32 v5, 0
v_mov_b32 v6, 0
v_mov_b32 v7, 0
v_mov_b32 v8, 0
v_mov_b32 v9, 0
v_mov_b32 v10, 0
v_mov_b32 v11, 0
v_mov_b32 v12, 0
v_mov_b32 v13, 0
v_mov_b32 v14, 0
v_mov_b32 v15, 0
v_mov_b32 v16, 0
v_mov_b32 v17, 0
v_mov_b32 v18, 0
v_mov_b32 v19, 0
v_mov_b32 v20, 0
v_mov_b32 v21, 0
v_mov_b32 v22, 0
v_mov_b32 v23, 0
v_mov_b32 v40, 0x3f803f80
v_mov_b32 v41, 0x3f803f80
v_mov_b32 v42, 0x3f803f80
v_mov_b32 v43, 0x3f803f80
ds_read_b64_tr_b16 v[28:29], v244 offset:0
ds_read_b64_tr_b16 v[30:31], v245 offset:0
ds_read_b64_tr_b16 v[32:33], v244 offset:32
ds_read_b64_tr_b16 v[34:35], v245 offset:32
ds_read_b64_tr_b16 v[36:37], v244 offset:160
ds_read_b64_tr_b16 v[38:39], v245 offset:160
ds_read_b64_tr_b16 v[44:45], v244 offset:192
ds_read_b64_tr_b16 v[46:47], v245 offset:192
s_waitcnt lgkmcnt(0)
v_mfma_f32_16x16x32_bf16 v[0:3], v[28:31], v[36:39], v[0:3]
v_mfma_f32_16x16x32_bf16 v[4:7], v[28:31], v[44:47], v[4:7]
v_mfma_f32_16x16x32_bf16 v[8:11], v[28:31], v[40:43], v[8:11]
v_mfma_f32_16x16x32_bf16 v[12:15], v[32:35], v[36:39], v[12:15]
v_mfma_f32_16x16x32_bf16 v[16:19], v[32:35], v[44:47], v[16:19]
v_mfma_f32_16x16x32_bf16 v[20:23], v[32:35], v[40:43], v[20:23]
ds_read_b64_tr_b16 v[28:29], v244 offset:10240
ds_read_b64_tr_b16 v[30:31], v245 offset:10240
ds_read_b64_tr_b16 v[32:33], v244 offset:10272
ds_read_b64_tr_b16 v[34:35], v245 offset:10272
ds_read_b64_tr_b16 v[36:37], v244 offset:10400
ds_read_b64_tr_b16 v[38:39], v245 offset:10400
ds_read_b64_tr_b16 v[44:45], v244 offset:10432
ds_read_b64_tr_b16 v[46:47], v245 offset:10432
s_waitcnt lgkmcnt(0)
v_mfma_f32_16x16x32_bf16 v[0:3], v[28:31], v[36:39], v[0:3]
v_mfma_f32_16x16x32_bf16 v[4:7], v[28:31], v[44:47], v[4:7]
v_mfma_f32_16x16x32_bf16 v[8:11], v[28:31], v[40:43], v[8:11]
v_mfma_f32_16x16x32_bf16 v[12:15], v[32:35], v[36:39], v[12:15]
v_mfma_f32_16x16x32_bf16 v[16:19], v[32:35], v[44:47], v[16:19]
v_mfma_f32_16x16x32_bf16 v[20:23], v[32:35], v[40:43], v[20:23]
s_nop 7
s_nop 7
s_add_u32 s56, s36, 22020096
s_addc_u32 s57, s37, 0
s_mov_b32 s58, 1966080
s_mov_b32 s59, 0x00020000
s_lshl_b32 s10, s5, 2
s_add_u32 s10, s10, s3
s_lshl_b32 s11, s4, 5
s_add_u32 s10, s10, s11
s_mul_i32 s10, s10, 1920
v_lshlrev_b32 v241, 2, v253
s_movk_i32 s9, 384
v_mad_u32_u24 v241, v254, s9, v241
v_add_u32 v241, s10, v241
s_mov_b64 s[12:13], exec
v_cmp_gt_u32 vcc, 16, v253
s_nop 3
s_mov_b64 exec, vcc
buffer_store_dword v0, v241, s[56:59], 0 offen offset:0
buffer_store_dword v1, v241, s[56:59], 0 offen offset:96
buffer_store_dword v2, v241, s[56:59], 0 offen offset:192
buffer_store_dword v3, v241, s[56:59], 0 offen offset:288
s_mov_b64 exec, s[12:13]
v_cmp_gt_u32 vcc, 4, v253
s_nop 3
s_mov_b64 exec, vcc
buffer_store_dword v4, v241, s[56:59], 0 offen offset:64
buffer_store_dword v5, v241, s[56:59], 0 offen offset:160
buffer_store_dword v6, v241, s[56:59], 0 offen offset:256
buffer_store_dword v7, v241, s[56:59], 0 offen offset:352
s_mov_b64 exec, s[12:13]
v_cmp_gt_u32 vcc, 1, v253
s_nop 3
s_mov_b64 exec, vcc
buffer_store_dword v8, v241, s[56:59], 0 offen offset:80
buffer_store_dword v9, v241, s[56:59], 0 offen offset:176
buffer_store_dword v10, v241, s[56:59], 0 offen offset:272
buffer_store_dword v11, v241, s[56:59], 0 offen offset:368
s_mov_b64 exec, s[12:13]
v_cmp_gt_u32 vcc, 16, v253
v_cmp_eq_u32 s[14:15], 0, v254
s_nop 1
s_and_b64 vcc, vcc, s[14:15]
s_nop 3
s_mov_b64 exec, vcc
buffer_store_dword v12, v241, s[56:59], 0 offen offset:1536
buffer_store_dword v13, v241, s[56:59], 0 offen offset:1632
buffer_store_dword v14, v241, s[56:59], 0 offen offset:1728
buffer_store_dword v15, v241, s[56:59], 0 offen offset:1824
s_mov_b64 exec, s[12:13]
v_cmp_gt_u32 vcc, 4, v253
v_cmp_eq_u32 s[14:15], 0, v254
s_nop 1
s_and_b64 vcc, vcc, s[14:15]
s_nop 3
s_mov_b64 exec, vcc
buffer_store_dword v16, v241, s[56:59], 0 offen offset:1600
buffer_store_dword v17, v241, s[56:59], 0 offen offset:1696
buffer_store_dword v18, v241, s[56:59], 0 offen offset:1792
buffer_store_dword v19, v241, s[56:59], 0 offen offset:1888
s_mov_b64 exec, s[12:13]
v_cmp_gt_u32 vcc, 1, v253
v_cmp_eq_u32 s[14:15], 0, v254
s_nop 1
s_and_b64 vcc, vcc, s[14:15]
s_nop 3
s_mov_b64 exec, vcc
buffer_store_dword v20, v241, s[56:59], 0 offen offset:1616
buffer_store_dword v21, v241, s[56:59], 0 offen offset:1712
buffer_store_dword v22, v241, s[56:59], 0 offen offset:1808
buffer_store_dword v23, v241, s[56:59], 0 offen offset:1904
s_mov_b64 exec, s[12:13]
k1_kernel_end:
s_endpgm
.p2align 8
.globl k1b_kernel
.type k1b_kernel,@function
k1b_kernel:
s_cmp_ge_u32 s2, 256
s_cbranch_scc1 k1b_kernel_end
s_load_dwordx16 s[16:31], s[0:1], 0
s_load_dwordx4 s[32:35], s[0:1], 64
s_load_dwordx2 s[36:37], s[0:1], 80
s_waitcnt lgkmcnt(0)
s_and_b32 s4, s2, 7
s_lshl_b32 s4, s4, 2
s_lshr_b32 s5, s2, 3
s_and_b32 s6, s5, 3
s_add_u32 s4, s4, s6
s_lshr_b32 s5, s5, 2
s_add_u32 s44, s36, 22020096
s_addc_u32 s45, s37, 0
s_mov_b32 s46, 1966080
s_mov_b32 s47, 0x00020000
s_mov_b32 s48, s36
s_mov_b32 s49, s37
s_mov_b32 s50, 2621440
s_mov_b32 s51, 0x00020000
s_add_u32 s52, s36, 2621440
s_addc_u32 s53, s37, 0
s_mov_b32 s54, 2621440
s_mov_b32 s55, 0x00020000
s_mul_i32 s10, s5, 7680
v_lshlrev_b32 v1, 2, v0
v_mov_b32 v8, 0
v_mov_b32 v9, 0
v_mov_b32 v10, 0
v_mov_b32 v11, 0
v_mov_b32 v12, 0
v_mov_b32 v13, 0
v_mov_b32 v14, 0
v_mov_b32 v15, 0
v_mov_b32 v3, 0x7ffffff0
v_cmp_gt_u32 vcc, 128, v0
s_nop 1
v_cndmask_b32 v2, v3, v1, vcc
s_add_u32 s11, s10, 0
s_add_u32 s14, s11, 4096
buffer_load_dword v128, v1, s[44:47], s11 offen offset:0
buffer_load_dword v129, v1, s[44:47], s11 offen offset:1024
buffer_load_dword v130, v1, s[44:47], s11 offen offset:2048
buffer_load_dword v131, v1, s[44:47], s11 offen offset:3072
buffer_load_dword v132, v1, s[44:47], s14 offen offset:0
buffer_load_dword v133, v1, s[44:47], s14 offen offset:1024
buffer_load_dword v134, v1, s[44:47], s14 offen offset:2048
buffer_load_dword v135, v2, s[44:47], s14 offen offset:3072
s_add_u32 s11, s10, 61440
s_add_u32 s14, s11, 4096
buffer_load_dword v136, v1, s[44:47], s11 offen offset:0
buffer_load_dword v137, v1, s[44:47], s11 offen offset:1024
buffer_load_dword v138, v1, s[44:47], s11 offen offset:2048
buffer_load_dword v139, v1, s[44:47], s11 offen offset:3072
buffer_load_dword v140, v1, s[44:47], s14 offen offset:0
buffer_load_dword v141, v1, s[44:47], s14 offen offset:1024
buffer_load_dword v142, v1, s[44:47], s14 offen offset:2048
buffer_load_dword v143, v2, s[44:47], s14 offen offset:3072
s_add_u32 s11, s10, 122880
s_add_u32 s14, s11, 4096
buffer_load_dword v144, v1, s[44:47], s11 offen offset:0
buffer_load_dword v145, v1, s[44:47], s11 offen offset:1024
buffer_load_dword v146, v1, s[44:47], s11 offen offset:2048
buffer_load_dword v147, v1, s[44:47], s11 offen offset:3072
buffer_load_dword v148, v1, s[44:47], s14 offen offset:0
buffer_load_dword v149, v1, s[44:47], s14 offen offset:1024
buffer_load_dword v150, v1, s[44:47], s14 offen offset:2048
buffer_load_dword v151, v2, s[44:47], s14 offen offset:3072
s_add_u32 s11, s10, 184320
s_add_u32 s14, s11, 4096
buffer_load_dword v152, v1, s[44:47], s11 offen offset:0
buffer_load_dword v153, v1, s[44:47], s11 offen offset:1024
buffer_load_dword v154, v1, s[44:47], s11 offen offset:2048
buffer_load_dword v155, v1, s[44:47], s11 offen offset:3072
buffer_load_dword v156, v1, s[44:47], s14 offen offset:0
buffer_load_dword v157, v1, s[44:47], s14 offen offset:1024
buffer_load_dword v158, v1, s[44:47], s14 offen offset:2048
buffer_load_dword v159, v2, s[44:47], s14 offen offset:3072
s_add_u32 s11, s10, 245760
s_add_u32 s14, s11, 4096
buffer_load_dword v160, v1, s[44:47], s11 offen offset:0
buffer_load_dword v161, v1, s[44:47], s11 offen offset:1024
buffer_load_dword v162, v1, s[44:47], s11 offen offset:2048
buffer_load_dword v163, v1, s[44:47], s11 offen offset:3072
buffer_load_dword v164, v1, s[44:47], s14 offen offset:0
buffer_load_dword v165, v1, s[44:47], s14 offen offset:1024
buffer_load_dword v166, v1, s[44:47], s14 offen offset:2048
buffer_load_dword v167, v2, s[44:47], s14 offen offset:3072
s_add_u32 s11, s10, 307200
s_add_u32 s14, s11, 4096
buffer_load_dword v168, v1, s[44:47], s11 offen offset:0
buffer_load_dword v169, v1, s[44:47], s11 offen offset:1024
buffer_load_dword v170, v1, s[44:47], s11 offen offset:2048
buffer_load_dword v171, v1, s[44:47], s11 offen offset:3072
buffer_load_dword v172, v1, s[44:47], s14 offen offset:0
buffer_load_dword v173, v1, s[44:47], s14 offen offset:1024
buffer_load_dword v174, v1, s[44:47], s14 offen offset:2048
buffer_load_dword v175, v2, s[44:47], s14 offen offset:3072
s_add_u32 s11, s10, 368640
s_add_u32 s14, s11, 4096
buffer_load_dword v176, v1, s[44:47], s11 offen offset:0
buffer_load_dword v177, v1, s[44:47], s11 offen offset:1024
buffer_load_dword v178, v1, s[44:47], s11 offen offset:2048
buffer_load_dword v179, v1, s[44:47], s11 offen offset:3072
buffer_load_dword v180, v1, s[44:47], s14 offen offset:0
buffer_load_dword v181, v1, s[44:47], s14 offen offset:1024
buffer_load_dword v182, v1, s[44:47], s14 offen offset:2048
buffer_load_dword v183, v2, s[44:47], s14 offen offset:3072
s_add_u32 s11, s10, 430080
s_add_u32 s14, s11, 4096
buffer_load_dword v184, v1, s[44:47], s11 offen offset:0
buffer_load_dword v185, v1, s[44:47], s11 offen offset:1024
buffer_load_dword v186, v1, s[44:47], s11 offen offset:2048
buffer_load_dword v187, v1, s[44:47], s11 offen offset:3072
buffer_load_dword v188, v1, s[44:47], s14 offen offset:0
buffer_load_dword v189, v1, s[44:47], s14 offen offset:1024
buffer_load_dword v190, v1, s[44:47], s14 offen offset:2048
buffer_load_dword v191, v2, s[44:47], s14 offen offset:3072
s_waitcnt vmcnt(56)
v_add_f32 v8, v8, v128
v_add_f32 v9, v9, v129
v_add_f32 v10, v10, v130
v_add_f32 v11, v11, v131
v_add_f32 v12, v12, v132
v_add_f32 v13, v13, v133
v_add_f32 v14, v14, v134
v_add_f32 v15, v15, v135
s_waitcnt vmcnt(48)
v_add_f32 v8, v8, v136
v_add_f32 v9, v9, v137
v_add_f32 v10, v10, v138
v_add_f32 v11, v11, v139
v_add_f32 v12, v12, v140
v_add_f32 v13, v13, v141
v_add_f32 v14, v14, v142
v_add_f32 v15, v15, v143
s_waitcnt vmcnt(40)
v_add_f32 v8, v8, v144
v_add_f32 v9, v9, v145
v_add_f32 v10, v10, v146
v_add_f32 v11, v11, v147
v_add_f32 v12, v12, v148
v_add_f32 v13, v13, v149
v_add_f32 v14, v14, v150
v_add_f32 v15, v15, v151
s_waitcnt vmcnt(32)
v_add_f32 v8, v8, v152
v_add_f32 v9, v9, v153
v_add_f32 v10, v10, v154
v_add_f32 v11, v11, v155
v_add_f32 v12, v12, v156
v_add_f32 v13, v13, v157
v_add_f32 v14, v14, v158
v_add_f32 v15, v15, v159
s_waitcnt vmcnt(24)
v_add_f32 v8, v8, v160
v_add_f32 v9, v9, v161
v_add_f32 v10, v10, v162
v_add_f32 v11, v11, v163
v_add_f32 v12, v12, v164
v_add_f32 v13, v13, v165
v_add_f32 v14, v14, v166
v_add_f32 v15, v15, v167
s_waitcnt vmcnt(16)
v_add_f32 v8, v8, v168
v_add_f32 v9, v9, v169
v_add_f32 v10, v10, v170
v_add_f32 v11, v11, v171
v_add_f32 v12, v12, v172
v_add_f32 v13, v13, v173
v_add_f32 v14, v14, v174
v_add_f32 v15, v15, v175
s_waitcnt vmcnt(8)
v_add_f32 v8, v8, v176
v_add_f32 v9, v9, v177
v_add_f32 v10, v10, v178
v_add_f32 v11, v11, v179
v_add_f32 v12, v12, v180
v_add_f32 v13, v13, v181
v_add_f32 v14, v14, v182
v_add_f32 v15, v15, v183
s_waitcnt vmcnt(0)
v_add_f32 v8, v8, v184
v_add_f32 v9, v9, v185
v_add_f32 v10, v10, v186
v_add_f32 v11, v11, v187
v_add_f32 v12, v12, v188
v_add_f32 v13, v13, v189
v_add_f32 v14, v14, v190
v_add_f32 v15, v15, v191
s_add_u32 s11, s10, 491520
s_add_u32 s14, s11, 4096
buffer_load_dword v128, v1, s[44:47], s11 offen offset:0
buffer_load_dword v129, v1, s[44:47], s11 offen offset:1024
buffer_load_dword v130, v1, s[44:47], s11 offen offset:2048
buffer_load_dword v131, v1, s[44:47], s11 offen offset:3072
buffer_load_dword v132, v1, s[44:47], s14 offen offset:0
buffer_load_dword v133, v1, s[44:47], s14 offen offset:1024
buffer_load_dword v134, v1, s[44:47], s14 offen offset:2048
buffer_load_dword v135, v2, s[44:47], s14 offen offset:3072
s_add_u32 s11, s10, 552960
s_add_u32 s14, s11, 4096
buffer_load_dword v136, v1, s[44:47], s11 offen offset:0
buffer_load_dword v137, v1, s[44:47], s11 offen offset:1024
buffer_load_dword v138, v1, s[44:47], s11 offen offset:2048
buffer_load_dword v139, v1, s[44:47], s11 offen offset:3072
buffer_load_dword v140, v1, s[44:47], s14 offen offset:0
buffer_load_dword v141, v1, s[44:47], s14 offen offset:1024
buffer_load_dword v142, v1, s[44:47], s14 offen offset:2048
buffer_load_dword v143, v2, s[44:47], s14 offen offset:3072
s_add_u32 s11, s10, 614400
s_add_u32 s14, s11, 4096
buffer_load_dword v144, v1, s[44:47], s11 offen offset:0
buffer_load_dword v145, v1, s[44:47], s11 offen offset:1024
buffer_load_dword v146, v1, s[44:47], s11 offen offset:2048
buffer_load_dword v147, v1, s[44:47], s11 offen offset:3072
buffer_load_dword v148, v1, s[44:47], s14 offen offset:0
buffer_load_dword v149, v1, s[44:47], s14 offen offset:1024
buffer_load_dword v150, v1, s[44:47], s14 offen offset:2048
buffer_load_dword v151, v2, s[44:47], s14 offen offset:3072
s_add_u32 s11, s10, 675840
s_add_u32 s14, s11, 4096
buffer_load_dword v152, v1, s[44:47], s11 offen offset:0
buffer_load_dword v153, v1, s[44:47], s11 offen offset:1024
buffer_load_dword v154, v1, s[44:47], s11 offen offset:2048
buffer_load_dword v155, v1, s[44:47], s11 offen offset:3072
buffer_load_dword v156, v1, s[44:47], s14 offen offset:0
buffer_load_dword v157, v1, s[44:47], s14 offen offset:1024
buffer_load_dword v158, v1, s[44:47], s14 offen offset:2048
buffer_load_dword v159, v2, s[44:47], s14 offen offset:3072
s_add_u32 s11, s10, 737280
s_add_u32 s14, s11, 4096
buffer_load_dword v160, v1, s[44:47], s11 offen offset:0
buffer_load_dword v161, v1, s[44:47], s11 offen offset:1024
buffer_load_dword v162, v1, s[44:47], s11 offen offset:2048
buffer_load_dword v163, v1, s[44:47], s11 offen offset:3072
buffer_load_dword v164, v1, s[44:47], s14 offen offset:0
buffer_load_dword v165, v1, s[44:47], s14 offen offset:1024
buffer_load_dword v166, v1, s[44:47], s14 offen offset:2048
buffer_load_dword v167, v2, s[44:47], s14 offen offset:3072
s_add_u32 s11, s10, 798720
s_add_u32 s14, s11, 4096
buffer_load_dword v168, v1, s[44:47], s11 offen offset:0
buffer_load_dword v169, v1, s[44:47], s11 offen offset:1024
buffer_load_dword v170, v1, s[44:47], s11 offen offset:2048
buffer_load_dword v171, v1, s[44:47], s11 offen offset:3072
buffer_load_dword v172, v1, s[44:47], s14 offen offset:0
buffer_load_dword v173, v1, s[44:47], s14 offen offset:1024
buffer_load_dword v174, v1, s[44:47], s14 offen offset:2048
buffer_load_dword v175, v2, s[44:47], s14 offen offset:3072
s_add_u32 s11, s10, 860160
s_add_u32 s14, s11, 4096
buffer_load_dword v176, v1, s[44:47], s11 offen offset:0
buffer_load_dword v177, v1, s[44:47], s11 offen offset:1024
buffer_load_dword v178, v1, s[44:47], s11 offen offset:2048
buffer_load_dword v179, v1, s[44:47], s11 offen offset:3072
buffer_load_dword v180, v1, s[44:47], s14 offen offset:0
buffer_load_dword v181, v1, s[44:47], s14 offen offset:1024
buffer_load_dword v182, v1, s[44:47], s14 offen offset:2048
buffer_load_dword v183, v2, s[44:47], s14 offen offset:3072
s_add_u32 s11, s10, 921600
s_add_u32 s14, s11, 4096
buffer_load_dword v184, v1, s[44:47], s11 offen offset:0
buffer_load_dword v185, v1, s[44:47], s11 offen offset:1024
buffer_load_dword v186, v1, s[44:47], s11 offen offset:2048
buffer_load_dword v187, v1, s[44:47], s11 offen offset:3072
buffer_load_dword v188, v1, s[44:47], s14 offen offset:0
buffer_load_dword v189, v1, s[44:47], s14 offen offset:1024
buffer_load_dword v190, v1, s[44:47], s14 offen offset:2048
buffer_load_dword v191, v2, s[44:47], s14 offen offset:3072
s_waitcnt vmcnt(56)
v_add_f32 v8, v8, v128
v_add_f32 v9, v9, v129
v_add_f32 v10, v10, v130
v_add_f32 v11, v11, v131
v_add_f32 v12, v12, v132
v_add_f32 v13, v13, v133
v_add_f32 v14, v14, v134
v_add_f32 v15, v15, v135
s_waitcnt vmcnt(48)
v_add_f32 v8, v8, v136
v_add_f32 v9, v9, v137
v_add_f32 v10, v10, v138
v_add_f32 v11, v11, v139
v_add_f32 v12, v12, v140
v_add_f32 v13, v13, v141
v_add_f32 v14, v14, v142
v_add_f32 v15, v15, v143
s_waitcnt vmcnt(40)
v_add_f32 v8, v8, v144
v_add_f32 v9, v9, v145
v_add_f32 v10, v10, v146
v_add_f32 v11, v11, v147
v_add_f32 v12, v12, v148
v_add_f32 v13, v13, v149
v_add_f32 v14, v14, v150
v_add_f32 v15, v15, v151
s_waitcnt vmcnt(32)
v_add_f32 v8, v8, v152
v_add_f32 v9, v9, v153
v_add_f32 v10, v10, v154
v_add_f32 v11, v11, v155
v_add_f32 v12, v12, v156
v_add_f32 v13, v13, v157
v_add_f32 v14, v14, v158
v_add_f32 v15, v15, v159
s_waitcnt vmcnt(24)
v_add_f32 v8, v8, v160
v_add_f32 v9, v9, v161
v_add_f32 v10, v10, v162
v_add_f32 v11, v11, v163
v_add_f32 v12, v12, v164
v_add_f32 v13, v13, v165
v_add_f32 v14, v14, v166
v_add_f32 v15, v15, v167
s_waitcnt vmcnt(16)
v_add_f32 v8, v8, v168
v_add_f32 v9, v9, v169
v_add_f32 v10, v10, v170
v_add_f32 v11, v11, v171
v_add_f32 v12, v12, v172
v_add_f32 v13, v13, v173
v_add_f32 v14, v14, v174
v_add_f32 v15, v15, v175
s_waitcnt vmcnt(8)
v_add_f32 v8, v8, v176
v_add_f32 v9, v9, v177
v_add_f32 v10, v10, v178
v_add_f32 v11, v11, v179
v_add_f32 v12, v12, v180
v_add_f32 v13, v13, v181
v_add_f32 v14, v14, v182
v_add_f32 v15, v15, v183
s_waitcnt vmcnt(0)
v_add_f32 v8, v8, v184
v_add_f32 v9, v9, v185
v_add_f32 v10, v10, v186
v_add_f32 v11, v11, v187
v_add_f32 v12, v12, v188
v_add_f32 v13, v13, v189
v_add_f32 v14, v14, v190
v_add_f32 v15, v15, v191
s_add_u32 s11, s10, 983040
s_add_u32 s14, s11, 4096
buffer_load_dword v128, v1, s[44:47], s11 offen offset:0
buffer_load_dword v129, v1, s[44:47], s11 offen offset:1024
buffer_load_dword v130, v1, s[44:47], s11 offen offset:2048
buffer_load_dword v131, v1, s[44:47], s11 offen offset:3072
buffer_load_dword v132, v1, s[44:47], s14 offen offset:0
buffer_load_dword v133, v1, s[44:47], s14 offen offset:1024
buffer_load_dword v134, v1, s[44:47], s14 offen offset:2048
buffer_load_dword v135, v2, s[44:47], s14 offen offset:3072
s_add_u32 s11, s10, 1044480
s_add_u32 s14, s11, 4096
buffer_load_dword v136, v1, s[44:47], s11 offen offset:0
buffer_load_dword v137, v1, s[44:47], s11 offen offset:1024
buffer_load_dword v138, v1, s[44:47], s11 offen offset:2048
buffer_load_dword v139, v1, s[44:47], s11 offen offset:3072
buffer_load_dword v140, v1, s[44:47], s14 offen offset:0
buffer_load_dword v141, v1, s[44:47], s14 offen offset:1024
buffer_load_dword v142, v1, s[44:47], s14 offen offset:2048
buffer_load_dword v143, v2, s[44:47], s14 offen offset:3072
s_add_u32 s11, s10, 1105920
s_add_u32 s14, s11, 4096
buffer_load_dword v144, v1, s[44:47], s11 offen offset:0
buffer_load_dword v145, v1, s[44:47], s11 offen offset:1024
buffer_load_dword v146, v1, s[44:47], s11 offen offset:2048
buffer_load_dword v147, v1, s[44:47], s11 offen offset:3072
buffer_load_dword v148, v1, s[44:47], s14 offen offset:0
buffer_load_dword v149, v1, s[44:47], s14 offen offset:1024
buffer_load_dword v150, v1, s[44:47], s14 offen offset:2048
buffer_load_dword v151, v2, s[44:47], s14 offen offset:3072
s_add_u32 s11, s10, 1167360
s_add_u32 s14, s11, 4096
buffer_load_dword v152, v1, s[44:47], s11 offen offset:0
buffer_load_dword v153, v1, s[44:47], s11 offen offset:1024
buffer_load_dword v154, v1, s[44:47], s11 offen offset:2048
buffer_load_dword v155, v1, s[44:47], s11 offen offset:3072
buffer_load_dword v156, v1, s[44:47], s14 offen offset:0
buffer_load_dword v157, v1, s[44:47], s14 offen offset:1024
buffer_load_dword v158, v1, s[44:47], s14 offen offset:2048
buffer_load_dword v159, v2, s[44:47], s14 offen offset:3072
s_add_u32 s11, s10, 1228800
s_add_u32 s14, s11, 4096
buffer_load_dword v160, v1, s[44:47], s11 offen offset:0
buffer_load_dword v161, v1, s[44:47], s11 offen offset:1024
buffer_load_dword v162, v1, s[44:47], s11 offen offset:2048
buffer_load_dword v163, v1, s[44:47], s11 offen offset:3072
buffer_load_dword v164, v1, s[44:47], s14 offen offset:0
buffer_load_dword v165, v1, s[44:47], s14 offen offset:1024
buffer_load_dword v166, v1, s[44:47], s14 offen offset:2048
buffer_load_dword v167, v2, s[44:47], s14 offen offset:3072
s_add_u32 s11, s10, 1290240
s_add_u32 s14, s11, 4096
buffer_load_dword v168, v1, s[44:47], s11 offen offset:0
buffer_load_dword v169, v1, s[44:47], s11 offen offset:1024
buffer_load_dword v170, v1, s[44:47], s11 offen offset:2048
buffer_load_dword v171, v1, s[44:47], s11 offen offset:3072
buffer_load_dword v172, v1, s[44:47], s14 offen offset:0
buffer_load_dword v173, v1, s[44:47], s14 offen offset:1024
buffer_load_dword v174, v1, s[44:47], s14 offen offset:2048
buffer_load_dword v175, v2, s[44:47], s14 offen offset:3072
s_add_u32 s11, s10, 1351680
s_add_u32 s14, s11, 4096
buffer_load_dword v176, v1, s[44:47], s11 offen offset:0
buffer_load_dword v177, v1, s[44:47], s11 offen offset:1024
buffer_load_dword v178, v1, s[44:47], s11 offen offset:2048
buffer_load_dword v179, v1, s[44:47], s11 offen offset:3072
buffer_load_dword v180, v1, s[44:47], s14 offen offset:0
buffer_load_dword v181, v1, s[44:47], s14 offen offset:1024
buffer_load_dword v182, v1, s[44:47], s14 offen offset:2048
buffer_load_dword v183, v2, s[44:47], s14 offen offset:3072
s_add_u32 s11, s10, 1413120
s_add_u32 s14, s11, 4096
buffer_load_dword v184, v1, s[44:47], s11 offen offset:0
buffer_load_dword v185, v1, s[44:47], s11 offen offset:1024
buffer_load_dword v186, v1, s[44:47], s11 offen offset:2048
buffer_load_dword v187, v1, s[44:47], s11 offen offset:3072
buffer_load_dword v188, v1, s[44:47], s14 offen offset:0
buffer_load_dword v189, v1, s[44:47], s14 offen offset:1024
buffer_load_dword v190, v1, s[44:47], s14 offen offset:2048
buffer_load_dword v191, v2, s[44:47], s14 offen offset:3072
s_waitcnt vmcnt(56)
v_add_f32 v8, v8, v128
v_add_f32 v9, v9, v129
v_add_f32 v10, v10, v130
v_add_f32 v11, v11, v131
v_add_f32 v12, v12, v132
v_add_f32 v13, v13, v133
v_add_f32 v14, v14, v134
v_add_f32 v15, v15, v135
s_waitcnt vmcnt(48)
v_add_f32 v8, v8, v136
v_add_f32 v9, v9, v137
v_add_f32 v10, v10, v138
v_add_f32 v11, v11, v139
v_add_f32 v12, v12, v140
v_add_f32 v13, v13, v141
v_add_f32 v14, v14, v142
v_add_f32 v15, v15, v143
s_waitcnt vmcnt(40)
v_add_f32 v8, v8, v144
v_add_f32 v9, v9, v145
v_add_f32 v10, v10, v146
v_add_f32 v11, v11, v147
v_add_f32 v12, v12, v148
v_add_f32 v13, v13, v149
v_add_f32 v14, v14, v150
v_add_f32 v15, v15, v151
s_waitcnt vmcnt(32)
v_add_f32 v8, v8, v152
v_add_f32 v9, v9, v153
v_add_f32 v10, v10, v154
v_add_f32 v11, v11, v155
v_add_f32 v12, v12, v156
v_add_f32 v13, v13, v157
v_add_f32 v14, v14, v158
v_add_f32 v15, v15, v159
s_waitcnt vmcnt(24)
v_add_f32 v8, v8, v160
v_add_f32 v9, v9, v161
v_add_f32 v10, v10, v162
v_add_f32 v11, v11, v163
v_add_f32 v12, v12, v164
v_add_f32 v13, v13, v165
v_add_f32 v14, v14, v166
v_add_f32 v15, v15, v167
s_waitcnt vmcnt(16)
v_add_f32 v8, v8, v168
v_add_f32 v9, v9, v169
v_add_f32 v10, v10, v170
v_add_f32 v11, v11, v171
v_add_f32 v12, v12, v172
v_add_f32 v13, v13, v173
v_add_f32 v14, v14, v174
v_add_f32 v15, v15, v175
s_waitcnt vmcnt(8)
v_add_f32 v8, v8, v176
v_add_f32 v9, v9, v177
v_add_f32 v10, v10, v178
v_add_f32 v11, v11, v179
v_add_f32 v12, v12, v180
v_add_f32 v13, v13, v181
v_add_f32 v14, v14, v182
v_add_f32 v15, v15, v183
s_waitcnt vmcnt(0)
v_add_f32 v8, v8, v184
v_add_f32 v9, v9, v185
v_add_f32 v10, v10, v186
v_add_f32 v11, v11, v187
v_add_f32 v12, v12, v188
v_add_f32 v13, v13, v189
v_add_f32 v14, v14, v190
v_add_f32 v15, v15, v191
s_add_u32 s11, s10, 1474560
s_add_u32 s14, s11, 4096
buffer_load_dword v128, v1, s[44:47], s11 offen offset:0
buffer_load_dword v129, v1, s[44:47], s11 offen offset:1024
buffer_load_dword v130, v1, s[44:47], s11 offen offset:2048
buffer_load_dword v131, v1, s[44:47], s11 offen offset:3072
buffer_load_dword v132, v1, s[44:47], s14 offen offset:0
buffer_load_dword v133, v1, s[44:47], s14 offen offset:1024
buffer_load_dword v134, v1, s[44:47], s14 offen offset:2048
buffer_load_dword v135, v2, s[44:47], s14 offen offset:3072
s_add_u32 s11, s10, 1536000
s_add_u32 s14, s11, 4096
buffer_load_dword v136, v1, s[44:47], s11 offen offset:0
buffer_load_dword v137, v1, s[44:47], s11 offen offset:1024
buffer_load_dword v138, v1, s[44:47], s11 offen offset:2048
buffer_load_dword v139, v1, s[44:47], s11 offen offset:3072
buffer_load_dword v140, v1, s[44:47], s14 offen offset:0
buffer_load_dword v141, v1, s[44:47], s14 offen offset:1024
buffer_load_dword v142, v1, s[44:47], s14 offen offset:2048
buffer_load_dword v143, v2, s[44:47], s14 offen offset:3072
s_add_u32 s11, s10, 1597440
s_add_u32 s14, s11, 4096
buffer_load_dword v144, v1, s[44:47], s11 offen offset:0
buffer_load_dword v145, v1, s[44:47], s11 offen offset:1024
buffer_load_dword v146, v1, s[44:47], s11 offen offset:2048
buffer_load_dword v147, v1, s[44:47], s11 offen offset:3072
buffer_load_dword v148, v1, s[44:47], s14 offen offset:0
buffer_load_dword v149, v1, s[44:47], s14 offen offset:1024
buffer_load_dword v150, v1, s[44:47], s14 offen offset:2048
buffer_load_dword v151, v2, s[44:47], s14 offen offset:3072
s_add_u32 s11, s10, 1658880
s_add_u32 s14, s11, 4096
buffer_load_dword v152, v1, s[44:47], s11 offen offset:0
buffer_load_dword v153, v1, s[44:47], s11 offen offset:1024
buffer_load_dword v154, v1, s[44:47], s11 offen offset:2048
buffer_load_dword v155, v1, s[44:47], s11 offen offset:3072
buffer_load_dword v156, v1, s[44:47], s14 offen offset:0
buffer_load_dword v157, v1, s[44:47], s14 offen offset:1024
buffer_load_dword v158, v1, s[44:47], s14 offen offset:2048
buffer_load_dword v159, v2, s[44:47], s14 offen offset:3072
s_add_u32 s11, s10, 1720320
s_add_u32 s14, s11, 4096
buffer_load_dword v160, v1, s[44:47], s11 offen offset:0
buffer_load_dword v161, v1, s[44:47], s11 offen offset:1024
buffer_load_dword v162, v1, s[44:47], s11 offen offset:2048
buffer_load_dword v163, v1, s[44:47], s11 offen offset:3072
buffer_load_dword v164, v1, s[44:47], s14 offen offset:0
buffer_load_dword v165, v1, s[44:47], s14 offen offset:1024
buffer_load_dword v166, v1, s[44:47], s14 offen offset:2048
buffer_load_dword v167, v2, s[44:47], s14 offen offset:3072
s_add_u32 s11, s10, 1781760
s_add_u32 s14, s11, 4096
buffer_load_dword v168, v1, s[44:47], s11 offen offset:0
buffer_load_dword v169, v1, s[44:47], s11 offen offset:1024
buffer_load_dword v170, v1, s[44:47], s11 offen offset:2048
buffer_load_dword v171, v1, s[44:47], s11 offen offset:3072
buffer_load_dword v172, v1, s[44:47], s14 offen offset:0
buffer_load_dword v173, v1, s[44:47], s14 offen offset:1024
buffer_load_dword v174, v1, s[44:47], s14 offen offset:2048
buffer_load_dword v175, v2, s[44:47], s14 offen offset:3072
s_add_u32 s11, s10, 1843200
s_add_u32 s14, s11, 4096
buffer_load_dword v176, v1, s[44:47], s11 offen offset:0
buffer_load_dword v177, v1, s[44:47], s11 offen offset:1024
buffer_load_dword v178, v1, s[44:47], s11 offen offset:2048
buffer_load_dword v179, v1, s[44:47], s11 offen offset:3072
buffer_load_dword v180, v1, s[44:47], s14 offen offset:0
buffer_load_dword v181, v1, s[44:47], s14 offen offset:1024
buffer_load_dword v182, v1, s[44:47], s14 offen offset:2048
buffer_load_dword v183, v2, s[44:47], s14 offen offset:3072
s_add_u32 s11, s10, 1904640
s_add_u32 s14, s11, 4096
buffer_load_dword v184, v1, s[44:47], s11 offen offset:0
buffer_load_dword v185, v1, s[44:47], s11 offen offset:1024
buffer_load_dword v186, v1, s[44:47], s11 offen offset:2048
buffer_load_dword v187, v1, s[44:47], s11 offen offset:3072
buffer_load_dword v188, v1, s[44:47], s14 offen offset:0
buffer_load_dword v189, v1, s[44:47], s14 offen offset:1024
buffer_load_dword v190, v1, s[44:47], s14 offen offset:2048
buffer_load_dword v191, v2, s[44:47], s14 offen offset:3072
s_waitcnt vmcnt(56)
v_add_f32 v8, v8, v128
v_add_f32 v9, v9, v129
v_add_f32 v10, v10, v130
v_add_f32 v11, v11, v131
v_add_f32 v12, v12, v132
v_add_f32 v13, v13, v133
v_add_f32 v14, v14, v134
v_add_f32 v15, v15, v135
s_waitcnt vmcnt(48)
v_add_f32 v8, v8, v136
v_add_f32 v9, v9, v137
v_add_f32 v10, v10, v138
v_add_f32 v11, v11, v139
v_add_f32 v12, v12, v140
v_add_f32 v13, v13, v141
v_add_f32 v14, v14, v142
v_add_f32 v15, v15, v143
s_waitcnt vmcnt(40)
v_add_f32 v8, v8, v144
v_add_f32 v9, v9, v145
v_add_f32 v10, v10, v146
v_add_f32 v11, v11, v147
v_add_f32 v12, v12, v148
v_add_f32 v13, v13, v149
v_add_f32 v14, v14, v150
v_add_f32 v15, v15, v151
s_waitcnt vmcnt(32)
v_add_f32 v8, v8, v152
v_add_f32 v9, v9, v153
v_add_f32 v10, v10, v154
v_add_f32 v11, v11, v155
v_add_f32 v12, v12, v156
v_add_f32 v13, v13, v157
v_add_f32 v14, v14, v158
v_add_f32 v15, v15, v159
s_waitcnt vmcnt(24)
v_add_f32 v8, v8, v160
v_add_f32 v9, v9, v161
v_add_f32 v10, v10, v162
v_add_f32 v11, v11, v163
v_add_f32 v12, v12, v164
v_add_f32 v13, v13, v165
v_add_f32 v14, v14, v166
v_add_f32 v15, v15, v167
s_waitcnt vmcnt(16)
v_add_f32 v8, v8, v168
v_add_f32 v9, v9, v169
v_add_f32 v10, v10, v170
v_add_f32 v11, v11, v171
v_add_f32 v12, v12, v172
v_add_f32 v13, v13, v173
v_add_f32 v14, v14, v174
v_add_f32 v15, v15, v175
s_waitcnt vmcnt(8)
v_add_f32 v8, v8, v176
v_add_f32 v9, v9, v177
v_add_f32 v10, v10, v178
v_add_f32 v11, v11, v179
v_add_f32 v12, v12, v180
v_add_f32 v13, v13, v181
v_add_f32 v14, v14, v182
v_add_f32 v15, v15, v183
s_waitcnt vmcnt(0)
v_add_f32 v8, v8, v184
v_add_f32 v9, v9, v185
v_add_f32 v10, v10, v186
v_add_f32 v11, v11, v187
v_add_f32 v12, v12, v188
v_add_f32 v13, v13, v189
v_add_f32 v14, v14, v190
v_add_f32 v15, v15, v191
v_cvt_pk_bf16_f32 v8, v8, v8
v_and_b32 v8, 0xffff0000, v8
ds_write_b32 v1, v8 offset:0
v_cvt_pk_bf16_f32 v9, v9, v9
v_and_b32 v9, 0xffff0000, v9
ds_write_b32 v1, v9 offset:1024
v_cvt_pk_bf16_f32 v10, v10, v10
v_and_b32 v10, 0xffff0000, v10
ds_write_b32 v1, v10 offset:2048
v_cvt_pk_bf16_f32 v11, v11, v11
v_and_b32 v11, 0xffff0000, v11
ds_write_b32 v1, v11 offset:3072
v_cvt_pk_bf16_f32 v12, v12, v12
v_and_b32 v12, 0xffff0000, v12
ds_write_b32 v1, v12 offset:4096
v_cvt_pk_bf16_f32 v13, v13, v13
v_and_b32 v13, 0xffff0000, v13
ds_write_b32 v1, v13 offset:5120
v_cvt_pk_bf16_f32 v14, v14, v14
v_and_b32 v14, 0xffff0000, v14
ds_write_b32 v1, v14 offset:6144
v_cvt_pk_bf16_f32 v15, v15, v15
v_and_b32 v15, 0xffff0000, v15
v_cmp_gt_u32 vcc, 128, v0
s_and_saveexec_b64 s[12:13], vcc
ds_write_b32 v1, v15 offset:7168
s_mov_b64 exec, s[12:13]
v_lshrrev_b32 v2, 2, v0
v_and_b32 v3, 3, v0
s_lshl_b32 s6, s4, 6
v_add_u32 v2, s6, v2
s_movk_i32 s9, 1280
v_mul_u32_u24 v4, 40, v3
v_mad_u32_u24 v4, v2, s9, v4
s_mul_i32 s10, s5, 160
v_add_u32 v4, s10, v4
buffer_load_dwordx2 v[30:31], v4, s[48:51], 0 offen offset:0
buffer_load_dwordx2 v[32:33], v4, s[48:51], 0 offen offset:8
buffer_load_dwordx2 v[34:35], v4, s[48:51], 0 offen offset:16
buffer_load_dwordx2 v[36:37], v4, s[48:51], 0 offen offset:24
buffer_load_dwordx2 v[38:39], v4, s[48:51], 0 offen offset:32
s_movk_i32 s9, 1920
v_mul_lo_u32 v5, v3, s9
s_waitcnt vmcnt(0) lgkmcnt(0)
s_barrier
v_lshlrev_b32 v40, 16, v30
v_and_b32 v41, 0xffff0000, v30
v_lshlrev_b32 v42, 16, v31
v_and_b32 v43, 0xffff0000, v31
v_lshlrev_b32 v44, 16, v32
v_and_b32 v45, 0xffff0000, v32
v_lshlrev_b32 v46, 16, v33
v_and_b32 v47, 0xffff0000, v33
v_lshlrev_b32 v48, 16, v34
v_and_b32 v49, 0xffff0000, v34
v_lshlrev_b32 v50, 16, v35
v_and_b32 v51, 0xffff0000, v35
v_lshlrev_b32 v52, 16, v36
v_and_b32 v53, 0xffff0000, v36
v_lshlrev_b32 v54, 16, v37
v_and_b32 v55, 0xffff0000, v37
v_lshlrev_b32 v56, 16, v38
v_and_b32 v57, 0xffff0000, v38
v_lshlrev_b32 v58, 16, v39
v_and_b32 v59, 0xffff0000, v39
v_mov_b32 v64, 0
v_mov_b32 v65, 0
v_mov_b32 v66, 0
v_mov_b32 v67, 0
v_mov_b32 v68, 0
v_mov_b32 v69, 0
v_mov_b32 v70, 0
v_mov_b32 v71, 0
v_mov_b32 v72, 0
v_mov_b32 v73, 0
v_mov_b32 v74, 0
v_mov_b32 v75, 0
v_mov_b32 v76, 0
v_mov_b32 v77, 0
v_mov_b32 v78, 0
v_mov_b32 v79, 0
v_mov_b32 v80, 0
v_mov_b32 v81, 0
v_mov_b32 v82, 0
v_mov_b32 v83, 0
v_mov_b32 v84, 0
v_mov_b32 v85, 0
v_mov_b32 v86, 0
v_mov_b32 v87, 0
ds_read_b128 v[100:103], v5 offset:0
ds_read_b128 v[104:107], v5 offset:16
ds_read_b128 v[108:111], v5 offset:32
ds_read_b128 v[112:115], v5 offset:48
ds_read_b128 v[116:119], v5 offset:64
ds_read_b128 v[120:123], v5 offset:80
s_waitcnt lgkmcnt(0)
v_fmac_f32 v64, v40, v100
v_fmac_f32 v65, v40, v101
v_fmac_f32 v66, v40, v102
v_fmac_f32 v67, v40, v103
v_fmac_f32 v68, v40, v104
v_fmac_f32 v69, v40, v105
v_fmac_f32 v70, v40, v106
v_fmac_f32 v71, v40, v107
v_fmac_f32 v72, v40, v108
v_fmac_f32 v73, v40, v109
v_fmac_f32 v74, v40, v110
v_fmac_f32 v75, v40, v111
v_fmac_f32 v76, v40, v112
v_fmac_f32 v77, v40, v113
v_fmac_f32 v78, v40, v114
v_fmac_f32 v79, v40, v115
v_fmac_f32 v80, v40, v116
v_fmac_f32 v81, v40, v117
v_fmac_f32 v82, v40, v118
v_fmac_f32 v83, v40, v119
v_fmac_f32 v84, v40, v120
ds_read_b128 v[100:103], v5 offset:96
ds_read_b128 v[104:107], v5 offset:112
ds_read_b128 v[108:111], v5 offset:128
ds_read_b128 v[112:115], v5 offset:144
ds_read_b128 v[116:119], v5 offset:160
ds_read_b128 v[120:123], v5 offset:176
s_waitcnt lgkmcnt(0)
v_fmac_f32 v64, v41, v100
v_fmac_f32 v65, v41, v101
v_fmac_f32 v66, v41, v102
v_fmac_f32 v67, v41, v103
v_fmac_f32 v68, v41, v104
v_fmac_f32 v69, v41, v105
v_fmac_f32 v70, v41, v106
v_fmac_f32 v71, v41, v107
v_fmac_f32 v72, v41, v108
v_fmac_f32 v73, v41, v109
v_fmac_f32 v74, v41, v110
v_fmac_f32 v75, v41, v111
v_fmac_f32 v76, v41, v112
v_fmac_f32 v77, v41, v113
v_fmac_f32 v78, v41, v114
v_fmac_f32 v79, v41, v115
v_fmac_f32 v80, v41, v116
v_fmac_f32 v81, v41, v117
v_fmac_f32 v82, v41, v118
v_fmac_f32 v83, v41, v119
v_fmac_f32 v84, v41, v120
ds_read_b128 v[100:103], v5 offset:192
ds_read_b128 v[104:107], v5 offset:208
ds_read_b128 v[108:111], v5 offset:224
ds_read_b128 v[112:115], v5 offset:240
ds_read_b128 v[116:119], v5 offset:256
ds_read_b128 v[120:123], v5 offset:272
s_waitcnt lgkmcnt(0)
v_fmac_f32 v64, v42, v100
v_fmac_f32 v65, v42, v101
v_fmac_f32 v66, v42, v102
v_fmac_f32 v67, v42, v103
v_fmac_f32 v68, v42, v104
v_fmac_f32 v69, v42, v105
v_fmac_f32 v70, v42, v106
v_fmac_f32 v71, v42, v107
v_fmac_f32 v72, v42, v108
v_fmac_f32 v73, v42, v109
v_fmac_f32 v74, v42, v110
v_fmac_f32 v75, v42, v111
v_fmac_f32 v76, v42, v112
v_fmac_f32 v77, v42, v113
v_fmac_f32 v78, v42, v114
v_fmac_f32 v79, v42, v115
v_fmac_f32 v80, v42, v116
v_fmac_f32 v81, v42, v117
v_fmac_f32 v82, v42, v118
v_fmac_f32 v83, v42, v119
v_fmac_f32 v84, v42, v120
ds_read_b128 v[100:103], v5 offset:288
ds_read_b128 v[104:107], v5 offset:304
ds_read_b128 v[108:111], v5 offset:320
ds_read_b128 v[112:115], v5 offset:336
ds_read_b128 v[116:119], v5 offset:352
ds_read_b128 v[120:123], v5 offset:368
s_waitcnt lgkmcnt(0)
v_fmac_f32 v64, v43, v100
v_fmac_f32 v65, v43, v101
v_fmac_f32 v66, v43, v102
v_fmac_f32 v67, v43, v103
v_fmac_f32 v68, v43, v104
v_fmac_f32 v69, v43, v105
v_fmac_f32 v70, v43, v106
v_fmac_f32 v71, v43, v107
v_fmac_f32 v72, v43, v108
v_fmac_f32 v73, v43, v109
v_fmac_f32 v74, v43, v110
v_fmac_f32 v75, v43, v111
v_fmac_f32 v76, v43, v112
v_fmac_f32 v77, v43, v113
v_fmac_f32 v78, v43, v114
v_fmac_f32 v79, v43, v115
v_fmac_f32 v80, v43, v116
v_fmac_f32 v81, v43, v117
v_fmac_f32 v82, v43, v118
v_fmac_f32 v83, v43, v119
v_fmac_f32 v84, v43, v120
ds_read_b128 v[100:103], v5 offset:384
ds_read_b128 v[104:107], v5 offset:400
ds_read_b128 v[108:111], v5 offset:416
ds_read_b128 v[112:115], v5 offset:432
ds_read_b128 v[116:119], v5 offset:448
ds_read_b128 v[120:123], v5 offset:464
s_waitcnt lgkmcnt(0)
v_fmac_f32 v64, v44, v100
v_fmac_f32 v65, v44, v101
v_fmac_f32 v66, v44, v102
v_fmac_f32 v67, v44, v103
v_fmac_f32 v68, v44, v104
v_fmac_f32 v69, v44, v105
v_fmac_f32 v70, v44, v106
v_fmac_f32 v71, v44, v107
v_fmac_f32 v72, v44, v108
v_fmac_f32 v73, v44, v109
v_fmac_f32 v74, v44, v110
v_fmac_f32 v75, v44, v111
v_fmac_f32 v76, v44, v112
v_fmac_f32 v77, v44, v113
v_fmac_f32 v78, v44, v114
v_fmac_f32 v79, v44, v115
v_fmac_f32 v80, v44, v116
v_fmac_f32 v81, v44, v117
v_fmac_f32 v82, v44, v118
v_fmac_f32 v83, v44, v119
v_fmac_f32 v84, v44, v120
ds_read_b128 v[100:103], v5 offset:480
ds_read_b128 v[104:107], v5 offset:496
ds_read_b128 v[108:111], v5 offset:512
ds_read_b128 v[112:115], v5 offset:528
ds_read_b128 v[116:119], v5 offset:544
ds_read_b128 v[120:123], v5 offset:560
s_waitcnt lgkmcnt(0)
v_fmac_f32 v64, v45, v100
v_fmac_f32 v65, v45, v101
v_fmac_f32 v66, v45, v102
v_fmac_f32 v67, v45, v103
v_fmac_f32 v68, v45, v104
v_fmac_f32 v69, v45, v105
v_fmac_f32 v70, v45, v106
v_fmac_f32 v71, v45, v107
v_fmac_f32 v72, v45, v108
v_fmac_f32 v73, v45, v109
v_fmac_f32 v74, v45, v110
v_fmac_f32 v75, v45, v111
v_fmac_f32 v76, v45, v112
v_fmac_f32 v77, v45, v113
v_fmac_f32 v78, v45, v114
v_fmac_f32 v79, v45, v115
v_fmac_f32 v80, v45, v116
v_fmac_f32 v81, v45, v117
v_fmac_f32 v82, v45, v118
v_fmac_f32 v83, v45, v119
v_fmac_f32 v84, v45, v120
ds_read_b128 v[100:103], v5 offset:576
ds_read_b128 v[104:107], v5 offset:592
ds_read_b128 v[108:111], v5 offset:608
ds_read_b128 v[112:115], v5 offset:624
ds_read_b128 v[116:119], v5 offset:640
ds_read_b128 v[120:123], v5 offset:656
s_waitcnt lgkmcnt(0)
v_fmac_f32 v64, v46, v100
v_fmac_f32 v65, v46, v101
v_fmac_f32 v66, v46, v102
v_fmac_f32 v67, v46, v103
v_fmac_f32 v68, v46, v104
v_fmac_f32 v69, v46, v105
v_fmac_f32 v70, v46, v106
v_fmac_f32 v71, v46, v107
v_fmac_f32 v72, v46, v108
v_fmac_f32 v73, v46, v109
v_fmac_f32 v74, v46, v110
v_fmac_f32 v75, v46, v111
v_fmac_f32 v76, v46, v112
v_fmac_f32 v77, v46, v113
v_fmac_f32 v78, v46, v114
v_fmac_f32 v79, v46, v115
v_fmac_f32 v80, v46, v116
v_fmac_f32 v81, v46, v117
v_fmac_f32 v82, v46, v118
v_fmac_f32 v83, v46, v119
v_fmac_f32 v84, v46, v120
ds_read_b128 v[100:103], v5 offset:672
ds_read_b128 v[104:107], v5 offset:688
ds_read_b128 v[108:111], v5 offset:704
ds_read_b128 v[112:115], v5 offset:720
ds_read_b128 v[116:119], v5 offset:736
ds_read_b128 v[120:123], v5 offset:752
s_waitcnt lgkmcnt(0)
v_fmac_f32 v64, v47, v100
v_fmac_f32 v65, v47, v101
v_fmac_f32 v66, v47, v102
v_fmac_f32 v67, v47, v103
v_fmac_f32 v68, v47, v104
v_fmac_f32 v69, v47, v105
v_fmac_f32 v70, v47, v106
v_fmac_f32 v71, v47, v107
v_fmac_f32 v72, v47, v108
v_fmac_f32 v73, v47, v109
v_fmac_f32 v74, v47, v110
v_fmac_f32 v75, v47, v111
v_fmac_f32 v76, v47, v112
v_fmac_f32 v77, v47, v113
v_fmac_f32 v78, v47, v114
v_fmac_f32 v79, v47, v115
v_fmac_f32 v80, v47, v116
v_fmac_f32 v81, v47, v117
v_fmac_f32 v82, v47, v118
v_fmac_f32 v83, v47, v119
v_fmac_f32 v84, v47, v120
ds_read_b128 v[100:103], v5 offset:768
ds_read_b128 v[104:107], v5 offset:784
ds_read_b128 v[108:111], v5 offset:800
ds_read_b128 v[112:115], v5 offset:816
ds_read_b128 v[116:119], v5 offset:832
ds_read_b128 v[120:123], v5 offset:848
s_waitcnt lgkmcnt(0)
v_fmac_f32 v64, v48, v100
v_fmac_f32 v65, v48, v101
v_fmac_f32 v66, v48, v102
v_fmac_f32 v67, v48, v103
v_fmac_f32 v68, v48, v104
v_fmac_f32 v69, v48, v105
v_fmac_f32 v70, v48, v106
v_fmac_f32 v71, v48, v107
v_fmac_f32 v72, v48, v108
v_fmac_f32 v73, v48, v109
v_fmac_f32 v74, v48, v110
v_fmac_f32 v75, v48, v111
v_fmac_f32 v76, v48, v112
v_fmac_f32 v77, v48, v113
v_fmac_f32 v78, v48, v114
v_fmac_f32 v79, v48, v115
v_fmac_f32 v80, v48, v116
v_fmac_f32 v81, v48, v117
v_fmac_f32 v82, v48, v118
v_fmac_f32 v83, v48, v119
v_fmac_f32 v84, v48, v120
ds_read_b128 v[100:103], v5 offset:864
ds_read_b128 v[104:107], v5 offset:880
ds_read_b128 v[108:111], v5 offset:896
ds_read_b128 v[112:115], v5 offset:912
ds_read_b128 v[116:119], v5 offset:928
ds_read_b128 v[120:123], v5 offset:944
s_waitcnt lgkmcnt(0)
v_fmac_f32 v64, v49, v100
v_fmac_f32 v65, v49, v101
v_fmac_f32 v66, v49, v102
v_fmac_f32 v67, v49, v103
v_fmac_f32 v68, v49, v104
v_fmac_f32 v69, v49, v105
v_fmac_f32 v70, v49, v106
v_fmac_f32 v71, v49, v107
v_fmac_f32 v72, v49, v108
v_fmac_f32 v73, v49, v109
v_fmac_f32 v74, v49, v110
v_fmac_f32 v75, v49, v111
v_fmac_f32 v76, v49, v112
v_fmac_f32 v77, v49, v113
v_fmac_f32 v78, v49, v114
v_fmac_f32 v79, v49, v115
v_fmac_f32 v80, v49, v116
v_fmac_f32 v81, v49, v117
v_fmac_f32 v82, v49, v118
v_fmac_f32 v83, v49, v119
v_fmac_f32 v84, v49, v120
ds_read_b128 v[100:103], v5 offset:960
ds_read_b128 v[104:107], v5 offset:976
ds_read_b128 v[108:111], v5 offset:992
ds_read_b128 v[112:115], v5 offset:1008
ds_read_b128 v[116:119], v5 offset:1024
ds_read_b128 v[120:123], v5 offset:1040
s_waitcnt lgkmcnt(0)
v_fmac_f32 v64, v50, v100
v_fmac_f32 v65, v50, v101
v_fmac_f32 v66, v50, v102
v_fmac_f32 v67, v50, v103
v_fmac_f32 v68, v50, v104
v_fmac_f32 v69, v50, v105
v_fmac_f32 v70, v50, v106
v_fmac_f32 v71, v50, v107
v_fmac_f32 v72, v50, v108
v_fmac_f32 v73, v50, v109
v_fmac_f32 v74, v50, v110
v_fmac_f32 v75, v50, v111
v_fmac_f32 v76, v50, v112
v_fmac_f32 v77, v50, v113
v_fmac_f32 v78, v50, v114
v_fmac_f32 v79, v50, v115
v_fmac_f32 v80, v50, v116
v_fmac_f32 v81, v50, v117
v_fmac_f32 v82, v50, v118
v_fmac_f32 v83, v50, v119
v_fmac_f32 v84, v50, v120
ds_read_b128 v[100:103], v5 offset:1056
ds_read_b128 v[104:107], v5 offset:1072
ds_read_b128 v[108:111], v5 offset:1088
ds_read_b128 v[112:115], v5 offset:1104
ds_read_b128 v[116:119], v5 offset:1120
ds_read_b128 v[120:123], v5 offset:1136
s_waitcnt lgkmcnt(0)
v_fmac_f32 v64, v51, v100
v_fmac_f32 v65, v51, v101
v_fmac_f32 v66, v51, v102
v_fmac_f32 v67, v51, v103
v_fmac_f32 v68, v51, v104
v_fmac_f32 v69, v51, v105
v_fmac_f32 v70, v51, v106
v_fmac_f32 v71, v51, v107
v_fmac_f32 v72, v51, v108
v_fmac_f32 v73, v51, v109
v_fmac_f32 v74, v51, v110
v_fmac_f32 v75, v51, v111
v_fmac_f32 v76, v51, v112
v_fmac_f32 v77, v51, v113
v_fmac_f32 v78, v51, v114
v_fmac_f32 v79, v51, v115
v_fmac_f32 v80, v51, v116
v_fmac_f32 v81, v51, v117
v_fmac_f32 v82, v51, v118
v_fmac_f32 v83, v51, v119
v_fmac_f32 v84, v51, v120
ds_read_b128 v[100:103], v5 offset:1152
ds_read_b128 v[104:107], v5 offset:1168
ds_read_b128 v[108:111], v5 offset:1184
ds_read_b128 v[112:115], v5 offset:1200
ds_read_b128 v[116:119], v5 offset:1216
ds_read_b128 v[120:123], v5 offset:1232
s_waitcnt lgkmcnt(0)
v_fmac_f32 v64, v52, v100
v_fmac_f32 v65, v52, v101
v_fmac_f32 v66, v52, v102
v_fmac_f32 v67, v52, v103
v_fmac_f32 v68, v52, v104
v_fmac_f32 v69, v52, v105
v_fmac_f32 v70, v52, v106
v_fmac_f32 v71, v52, v107
v_fmac_f32 v72, v52, v108
v_fmac_f32 v73, v52, v109
v_fmac_f32 v74, v52, v110
v_fmac_f32 v75, v52, v111
v_fmac_f32 v76, v52, v112
v_fmac_f32 v77, v52, v113
v_fmac_f32 v78, v52, v114
v_fmac_f32 v79, v52, v115
v_fmac_f32 v80, v52, v116
v_fmac_f32 v81, v52, v117
v_fmac_f32 v82, v52, v118
v_fmac_f32 v83, v52, v119
v_fmac_f32 v84, v52, v120
ds_read_b128 v[100:103], v5 offset:1248
ds_read_b128 v[104:107], v5 offset:1264
ds_read_b128 v[108:111], v5 offset:1280
ds_read_b128 v[112:115], v5 offset:1296
ds_read_b128 v[116:119], v5 offset:1312
ds_read_b128 v[120:123], v5 offset:1328
s_waitcnt lgkmcnt(0)
v_fmac_f32 v64, v53, v100
v_fmac_f32 v65, v53, v101
v_fmac_f32 v66, v53, v102
v_fmac_f32 v67, v53, v103
v_fmac_f32 v68, v53, v104
v_fmac_f32 v69, v53, v105
v_fmac_f32 v70, v53, v106
v_fmac_f32 v71, v53, v107
v_fmac_f32 v72, v53, v108
v_fmac_f32 v73, v53, v109
v_fmac_f32 v74, v53, v110
v_fmac_f32 v75, v53, v111
v_fmac_f32 v76, v53, v112
v_fmac_f32 v77, v53, v113
v_fmac_f32 v78, v53, v114
v_fmac_f32 v79, v53, v115
v_fmac_f32 v80, v53, v116
v_fmac_f32 v81, v53, v117
v_fmac_f32 v82, v53, v118
v_fmac_f32 v83, v53, v119
v_fmac_f32 v84, v53, v120
ds_read_b128 v[100:103], v5 offset:1344
ds_read_b128 v[104:107], v5 offset:1360
ds_read_b128 v[108:111], v5 offset:1376
ds_read_b128 v[112:115], v5 offset:1392
ds_read_b128 v[116:119], v5 offset:1408
ds_read_b128 v[120:123], v5 offset:1424
s_waitcnt lgkmcnt(0)
v_fmac_f32 v64, v54, v100
v_fmac_f32 v65, v54, v101
v_fmac_f32 v66, v54, v102
v_fmac_f32 v67, v54, v103
v_fmac_f32 v68, v54, v104
v_fmac_f32 v69, v54, v105
v_fmac_f32 v70, v54, v106
v_fmac_f32 v71, v54, v107
v_fmac_f32 v72, v54, v108
v_fmac_f32 v73, v54, v109
v_fmac_f32 v74, v54, v110
v_fmac_f32 v75, v54, v111
v_fmac_f32 v76, v54, v112
v_fmac_f32 v77, v54, v113
v_fmac_f32 v78, v54, v114
v_fmac_f32 v79, v54, v115
v_fmac_f32 v80, v54, v116
v_fmac_f32 v81, v54, v117
v_fmac_f32 v82, v54, v118
v_fmac_f32 v83, v54, v119
v_fmac_f32 v84, v54, v120
ds_read_b128 v[100:103], v5 offset:1440
ds_read_b128 v[104:107], v5 offset:1456
ds_read_b128 v[108:111], v5 offset:1472
ds_read_b128 v[112:115], v5 offset:1488
ds_read_b128 v[116:119], v5 offset:1504
ds_read_b128 v[120:123], v5 offset:1520
s_waitcnt lgkmcnt(0)
v_fmac_f32 v64, v55, v100
v_fmac_f32 v65, v55, v101
v_fmac_f32 v66, v55, v102
v_fmac_f32 v67, v55, v103
v_fmac_f32 v68, v55, v104
v_fmac_f32 v69, v55, v105
v_fmac_f32 v70, v55, v106
v_fmac_f32 v71, v55, v107
v_fmac_f32 v72, v55, v108
v_fmac_f32 v73, v55, v109
v_fmac_f32 v74, v55, v110
v_fmac_f32 v75, v55, v111
v_fmac_f32 v76, v55, v112
v_fmac_f32 v77, v55, v113
v_fmac_f32 v78, v55, v114
v_fmac_f32 v79, v55, v115
v_fmac_f32 v80, v55, v116
v_fmac_f32 v81, v55, v117
v_fmac_f32 v82, v55, v118
v_fmac_f32 v83, v55, v119
v_fmac_f32 v84, v55, v120
ds_read_b128 v[100:103], v5 offset:1536
ds_read_b128 v[104:107], v5 offset:1552
ds_read_b128 v[108:111], v5 offset:1568
ds_read_b128 v[112:115], v5 offset:1584
ds_read_b128 v[116:119], v5 offset:1600
ds_read_b128 v[120:123], v5 offset:1616
s_waitcnt lgkmcnt(0)
v_fmac_f32 v64, v56, v100
v_fmac_f32 v65, v56, v101
v_fmac_f32 v66, v56, v102
v_fmac_f32 v67, v56, v103
v_fmac_f32 v68, v56, v104
v_fmac_f32 v69, v56, v105
v_fmac_f32 v70, v56, v106
v_fmac_f32 v71, v56, v107
v_fmac_f32 v72, v56, v108
v_fmac_f32 v73, v56, v109
v_fmac_f32 v74, v56, v110
v_fmac_f32 v75, v56, v111
v_fmac_f32 v76, v56, v112
v_fmac_f32 v77, v56, v113
v_fmac_f32 v78, v56, v114
v_fmac_f32 v79, v56, v115
v_fmac_f32 v80, v56, v116
v_fmac_f32 v81, v56, v117
v_fmac_f32 v82, v56, v118
v_fmac_f32 v83, v56, v119
v_fmac_f32 v84, v56, v120
ds_read_b128 v[100:103], v5 offset:1632
ds_read_b128 v[104:107], v5 offset:1648
ds_read_b128 v[108:111], v5 offset:1664
ds_read_b128 v[112:115], v5 offset:1680
ds_read_b128 v[116:119], v5 offset:1696
ds_read_b128 v[120:123], v5 offset:1712
s_waitcnt lgkmcnt(0)
v_fmac_f32 v64, v57, v100
v_fmac_f32 v65, v57, v101
v_fmac_f32 v66, v57, v102
v_fmac_f32 v67, v57, v103
v_fmac_f32 v68, v57, v104
v_fmac_f32 v69, v57, v105
v_fmac_f32 v70, v57, v106
v_fmac_f32 v71, v57, v107
v_fmac_f32 v72, v57, v108
v_fmac_f32 v73, v57, v109
v_fmac_f32 v74, v57, v110
v_fmac_f32 v75, v57, v111
v_fmac_f32 v76, v57, v112
v_fmac_f32 v77, v57, v113
v_fmac_f32 v78, v57, v114
v_fmac_f32 v79, v57, v115
v_fmac_f32 v80, v57, v116
v_fmac_f32 v81, v57, v117
v_fmac_f32 v82, v57, v118
v_fmac_f32 v83, v57, v119
v_fmac_f32 v84, v57, v120
ds_read_b128 v[100:103], v5 offset:1728
ds_read_b128 v[104:107], v5 offset:1744
ds_read_b128 v[108:111], v5 offset:1760
ds_read_b128 v[112:115], v5 offset:1776
ds_read_b128 v[116:119], v5 offset:1792
ds_read_b128 v[120:123], v5 offset:1808
s_waitcnt lgkmcnt(0)
v_fmac_f32 v64, v58, v100
v_fmac_f32 v65, v58, v101
v_fmac_f32 v66, v58, v102
v_fmac_f32 v67, v58, v103
v_fmac_f32 v68, v58, v104
v_fmac_f32 v69, v58, v105
v_fmac_f32 v70, v58, v106
v_fmac_f32 v71, v58, v107
v_fmac_f32 v72, v58, v108
v_fmac_f32 v73, v58, v109
v_fmac_f32 v74, v58, v110
v_fmac_f32 v75, v58, v111
v_fmac_f32 v76, v58, v112
v_fmac_f32 v77, v58, v113
v_fmac_f32 v78, v58, v114
v_fmac_f32 v79, v58, v115
v_fmac_f32 v80, v58, v116
v_fmac_f32 v81, v58, v117
v_fmac_f32 v82, v58, v118
v_fmac_f32 v83, v58, v119
v_fmac_f32 v84, v58, v120
ds_read_b128 v[100:103], v5 offset:1824
ds_read_b128 v[104:107], v5 offset:1840
ds_read_b128 v[108:111], v5 offset:1856
ds_read_b128 v[112:115], v5 offset:1872
ds_read_b128 v[116:119], v5 offset:1888
ds_read_b128 v[120:123], v5 offset:1904
s_waitcnt lgkmcnt(0)
v_fmac_f32 v64, v59, v100
v_fmac_f32 v65, v59, v101
v_fmac_f32 v66, v59, v102
v_fmac_f32 v67, v59, v103
v_fmac_f32 v68, v59, v104
v_fmac_f32 v69, v59, v105
v_fmac_f32 v70, v59, v106
v_fmac_f32 v71, v59, v107
v_fmac_f32 v72, v59, v108
v_fmac_f32 v73, v59, v109
v_fmac_f32 v74, v59, v110
v_fmac_f32 v75, v59, v111
v_fmac_f32 v76, v59, v112
v_fmac_f32 v77, v59, v113
v_fmac_f32 v78, v59, v114
v_fmac_f32 v79, v59, v115
v_fmac_f32 v80, v59, v116
v_fmac_f32 v81, v59, v117
v_fmac_f32 v82, v59, v118
v_fmac_f32 v83, v59, v119
v_fmac_f32 v84, v59, v120
v_cvt_pk_bf16_f32 v84, v84, v84
v_and_b32 v84, 0xffff0000, v84
v_add_f32 v84, 0x358637bd, v84
v_cvt_pk_bf16_f32 v84, v84, v84
v_and_b32 v84, 0xffff0000, v84
v_rcp_f32 v84, v84
s_nop 0
v_cvt_pk_bf16_f32 v64, v64, v64
v_and_b32 v64, 0xffff0000, v64
v_mul_f32 v64, v64, v84
v_cvt_pk_bf16_f32 v65, v65, v65
v_and_b32 v65, 0xffff0000, v65
v_mul_f32 v65, v65, v84
v_cvt_pk_bf16_f32 v66, v66, v66
v_and_b32 v66, 0xffff0000, v66
v_mul_f32 v66, v66, v84
v_cvt_pk_bf16_f32 v67, v67, v67
v_and_b32 v67, 0xffff0000, v67
v_mul_f32 v67, v67, v84
v_cvt_pk_bf16_f32 v68, v68, v68
v_and_b32 v68, 0xffff0000, v68
v_mul_f32 v68, v68, v84
v_cvt_pk_bf16_f32 v69, v69, v69
v_and_b32 v69, 0xffff0000, v69
v_mul_f32 v69, v69, v84
v_cvt_pk_bf16_f32 v70, v70, v70
v_and_b32 v70, 0xffff0000, v70
v_mul_f32 v70, v70, v84
v_cvt_pk_bf16_f32 v71, v71, v71
v_and_b32 v71, 0xffff0000, v71
v_mul_f32 v71, v71, v84
v_cvt_pk_bf16_f32 v72, v72, v72
v_and_b32 v72, 0xffff0000, v72
v_mul_f32 v72, v72, v84
v_cvt_pk_bf16_f32 v73, v73, v73
v_and_b32 v73, 0xffff0000, v73
v_mul_f32 v73, v73, v84
v_cvt_pk_bf16_f32 v74, v74, v74
v_and_b32 v74, 0xffff0000, v74
v_mul_f32 v74, v74, v84
v_cvt_pk_bf16_f32 v75, v75, v75
v_and_b32 v75, 0xffff0000, v75
v_mul_f32 v75, v75, v84
v_cvt_pk_bf16_f32 v76, v76, v76
v_and_b32 v76, 0xffff0000, v76
v_mul_f32 v76, v76, v84
v_cvt_pk_bf16_f32 v77, v77, v77
v_and_b32 v77, 0xffff0000, v77
v_mul_f32 v77, v77, v84
v_cvt_pk_bf16_f32 v78, v78, v78
v_and_b32 v78, 0xffff0000, v78
v_mul_f32 v78, v78, v84
v_cvt_pk_bf16_f32 v79, v79, v79
v_and_b32 v79, 0xffff0000, v79
v_mul_f32 v79, v79, v84
v_cvt_pk_bf16_f32 v80, v80, v80
v_and_b32 v80, 0xffff0000, v80
v_mul_f32 v80, v80, v84
v_cvt_pk_bf16_f32 v81, v81, v81
v_and_b32 v81, 0xffff0000, v81
v_mul_f32 v81, v81, v84
v_cvt_pk_bf16_f32 v82, v82, v82
v_and_b32 v82, 0xffff0000, v82
v_mul_f32 v82, v82, v84
v_cvt_pk_bf16_f32 v83, v83, v83
v_and_b32 v83, 0xffff0000, v83
v_mul_f32 v83, v83, v84
v_cvt_pk_bf16_f32 v30, v64, v65
v_cvt_pk_bf16_f32 v31, v66, v67
v_cvt_pk_bf16_f32 v32, v68, v69
v_cvt_pk_bf16_f32 v33, v70, v71
v_cvt_pk_bf16_f32 v34, v72, v73
v_cvt_pk_bf16_f32 v35, v74, v75
v_cvt_pk_bf16_f32 v36, v76, v77
v_cvt_pk_bf16_f32 v37, v78, v79
v_cvt_pk_bf16_f32 v38, v80, v81
v_cvt_pk_bf16_f32 v39, v82, v83
buffer_store_dwordx2 v[30:31], v4, s[52:55], 0 offen offset:0
buffer_store_dwordx2 v[32:33], v4, s[52:55], 0 offen offset:8
buffer_store_dwordx2 v[34:35], v4, s[52:55], 0 offen offset:16
buffer_store_dwordx2 v[36:37], v4, s[52:55], 0 offen offset:24
buffer_store_dwordx2 v[38:39], v4, s[52:55], 0 offen offset:32
k1b_kernel_end:
s_endpgm
.p2align 8
.globl k2_kernel
.type k2_kernel,@function
k2_kernel:
s_cmp_ge_u32 s2, 256
s_cbranch_scc1 k2_kernel_end
s_load_dwordx16 s[16:31], s[0:1], 0
s_load_dwordx4 s[32:35], s[0:1], 64
s_load_dwordx2 s[36:37], s[0:1], 80
s_mov_b32 s40, 0x3d372713
s_mov_b32 s41, 0xc0135761
s_mov_b32 s42, 0x3acccccd
v_and_b32 v252, 63, v0
v_lshrrev_b32 v253, 6, v0
s_nop 0
v_readfirstlane_b32 s3, v253
v_and_b32 v253, 15, v252
v_lshrrev_b32 v254, 4, v252
v_xor_b32 v250, 16, v252
v_lshlrev_b32 v250, 2, v250
v_xor_b32 v251, 32, v252
v_lshlrev_b32 v251, 2, v251
s_and_b32 s4, s2, 7
s_lshl_b32 s4, s4, 2
s_lshr_b32 s5, s2, 3
s_and_b32 s6, s5, 3
s_add_u32 s4, s4, s6
s_lshr_b32 s5, s5, 2
s_lshl_b32 s6, s4, 6
s_lshl_b32 s7, s3, 4
s_add_u32 s6, s6, s7
v_add_u32 v255, s6, v253
s_waitcnt lgkmcnt(0)
s_add_u32 s44, s36, 2621440
s_addc_u32 s45, s37, 0
s_mov_b32 s46, 2621440
s_mov_b32 s47, 0x00020000
s_mov_b32 s48, s20
s_mov_b32 s49, s21
s_mov_b32 s50, 819200
s_mov_b32 s51, 0x00020000
s_mul_i32 s8, s3, 5120
v_lshlrev_b32 v240, 4, v252
v_add_u32 v240, s8, v240
v_add_u32 v240, 0, v240
v_cvt_f32_u32 v241, v240
s_mov_b32 s9, 0x3bcccccd
v_add_f32 v241, 0.5, v241
v_mul_f32 v241, s9, v241
v_cvt_u32_f32 v241, v241
s_movk_i32 s9, 160
v_mul_lo_u32 v242, v241, s9
v_sub_u32 v242, v240, v242
s_movk_i32 s9, 1280
v_mad_u32_u24 v192, v241, s9, v242
s_mul_i32 s8, s3, 5120
v_lshlrev_b32 v240, 4, v252
v_add_u32 v240, s8, v240
v_add_u32 v240, 1024, v240
v_cvt_f32_u32 v241, v240
s_mov_b32 s9, 0x3bcccccd
v_add_f32 v241, 0.5, v241
v_mul_f32 v241, s9, v241
v_cvt_u32_f32 v241, v241
s_movk_i32 s9, 160
v_mul_lo_u32 v242, v241, s9
v_sub_u32 v242, v240, v242
s_movk_i32 s9, 1280
v_mad_u32_u24 v193, v241, s9, v242
s_mul_i32 s8, s3, 5120
v_lshlrev_b32 v240, 4, v252
v_add_u32 v240, s8, v240
v_add_u32 v240, 2048, v240
v_cvt_f32_u32 v241, v240
s_mov_b32 s9, 0x3bcccccd
v_add_f32 v241, 0.5, v241
v_mul_f32 v241, s9, v241
v_cvt_u32_f32 v241, v241
s_movk_i32 s9, 160
v_mul_lo_u32 v242, v241, s9
v_sub_u32 v242, v240, v242
s_movk_i32 s9, 1280
v_mad_u32_u24 v194, v241, s9, v242
s_mul_i32 s8, s3, 5120
v_lshlrev_b32 v240, 4, v252
v_add_u32 v240, s8, v240
v_add_u32 v240, 3072, v240
v_cvt_f32_u32 v241, v240
s_mov_b32 s9, 0x3bcccccd
v_add_f32 v241, 0.5, v241
v_mul_f32 v241, s9, v241
v_cvt_u32_f32 v241, v241
s_movk_i32 s9, 160
v_mul_lo_u32 v242, v241, s9
v_sub_u32 v242, v240, v242
s_movk_i32 s9, 1280
v_mad_u32_u24 v195, v241, s9, v242
s_mul_i32 s8, s3, 5120
v_lshlrev_b32 v240, 4, v252
v_add_u32 v240, s8, v240
v_add_u32 v240, 4096, v240
v_cvt_f32_u32 v241, v240
s_mov_b32 s9, 0x3bcccccd
v_add_f32 v241, 0.5, v241
v_mul_f32 v241, s9, v241
v_cvt_u32_f32 v241, v241
s_movk_i32 s9, 160
v_mul_lo_u32 v242, v241, s9
v_sub_u32 v242, v240, v242
s_movk_i32 s9, 1280
v_mad_u32_u24 v196, v241, s9, v242
s_mul_i32 s10, s5, 160
s_mul_i32 s13, s3, 5120
s_add_u32 s13, s13, 81920
s_mov_b32 s14, 0
v_and_b32 v240, 1, v254
v_mov_b32 v241, 0
v_lshl_add_u32 v241, v254, 4, v241
s_movk_i32 s9, 1280
v_mad_u32_u24 v248, v255, s9, v241
v_mov_b32 v241, 8
v_lshl_add_u32 v241, v254, 4, v241
s_movk_i32 s9, 1280
v_mad_u32_u24 v249, v255, s9, v241
s_mul_i32 s12, s5, 160
v_lshlrev_b32 v241, 3, v254
v_add_u32 v241, s12, v241
s_movk_i32 s9, 1280
v_mad_u32_u24 v240, v255, s9, v241
s_mov_b32 s56, s16
s_mov_b32 s57, s17
s_mov_b32 s58, 2621440
s_mov_b32 s59, 0x00020000
buffer_load_dwordx2 a[64:65], v240, s[56:59], 0 offen offset:0
buffer_load_dwordx2 a[66:67], v240, s[56:59], 0 offen offset:32
buffer_load_dwordx2 a[68:69], v240, s[56:59], 0 offen offset:64
buffer_load_dwordx2 a[70:71], v240, s[56:59], 0 offen offset:96
buffer_load_dwordx2 a[72:73], v240, s[56:59], 0 offen offset:128
v_accvgpr_write_b32 a0, 0
v_accvgpr_write_b32 a1, 0
v_accvgpr_write_b32 a2, 0
v_accvgpr_write_b32 a3, 0
v_accvgpr_write_b32 a4, 0
v_accvgpr_write_b32 a5, 0
v_accvgpr_write_b32 a6, 0
v_accvgpr_write_b32 a7, 0
v_accvgpr_write_b32 a8, 0
v_accvgpr_write_b32 a9, 0
v_accvgpr_write_b32 a10, 0
v_accvgpr_write_b32 a11, 0
v_accvgpr_write_b32 a12, 0
v_accvgpr_write_b32 a13, 0
v_accvgpr_write_b32 a14, 0
v_accvgpr_write_b32 a15, 0
v_accvgpr_write_b32 a16, 0
v_accvgpr_write_b32 a17, 0
v_accvgpr_write_b32 a18, 0
v_accvgpr_write_b32 a19, 0
v_lshlrev_b32 v236, 4, v252
s_mul_i32 s8, s3, 20480
v_add_u32 v236, s8, v236
s_mul_i32 s8, s3, 20480
s_add_u32 m0, s8, 0
s_movk_i32 s9, 0
buffer_load_dwordx4 v248, s[44:47], s9 offen lds
s_mul_i32 s8, s3, 20480
s_add_u32 m0, s8, 1024
s_movk_i32 s9, 64
buffer_load_dwordx4 v248, s[44:47], s9 offen lds
s_mul_i32 s8, s3, 20480
s_add_u32 m0, s8, 2048
s_movk_i32 s9, 128
buffer_load_dwordx4 v248, s[44:47], s9 offen lds
s_mul_i32 s8, s3, 20480
s_add_u32 m0, s8, 3072
s_movk_i32 s9, 192
buffer_load_dwordx4 v248, s[44:47], s9 offen lds
s_mul_i32 s8, s3, 20480
s_add_u32 m0, s8, 4096
s_movk_i32 s9, 256
buffer_load_dwordx4 v248, s[44:47], s9 offen lds
s_mul_i32 s8, s3, 20480
s_add_u32 m0, s8, 5120
s_movk_i32 s9, 320
buffer_load_dwordx4 v248, s[44:47], s9 offen lds
s_mul_i32 s8, s3, 20480
s_add_u32 m0, s8, 6144
s_movk_i32 s9, 384
buffer_load_dwordx4 v248, s[44:47], s9 offen lds
s_mul_i32 s8, s3, 20480
s_add_u32 m0, s8, 7168
s_movk_i32 s9, 448
buffer_load_dwordx4 v248, s[44:47], s9 offen lds
s_mul_i32 s8, s3, 20480
s_add_u32 m0, s8, 8192
s_movk_i32 s9, 512
buffer_load_dwordx4 v248, s[44:47], s9 offen lds
s_mul_i32 s8, s3, 20480
s_add_u32 m0, s8, 9216
s_movk_i32 s9, 576
buffer_load_dwordx4 v248, s[44:47], s9 offen lds
s_mul_i32 s8, s3, 20480
s_add_u32 m0, s8, 10240
s_movk_i32 s9, 640
buffer_load_dwordx4 v248, s[44:47], s9 offen lds
s_mul_i32 s8, s3, 20480
s_add_u32 m0, s8, 11264
s_movk_i32 s9, 704
buffer_load_dwordx4 v248, s[44:47], s9 offen lds
s_mul_i32 s8, s3, 20480
s_add_u32 m0, s8, 12288
s_movk_i32 s9, 768
buffer_load_dwordx4 v248, s[44:47], s9 offen lds
s_mul_i32 s8, s3, 20480
s_add_u32 m0, s8, 13312
s_movk_i32 s9, 832
buffer_load_dwordx4 v248, s[44:47], s9 offen lds
s_mul_i32 s8, s3, 20480
s_add_u32 m0, s8, 14336
s_movk_i32 s9, 896
buffer_load_dwordx4 v248, s[44:47], s9 offen lds
s_mul_i32 s8, s3, 20480
s_add_u32 m0, s8, 15360
s_movk_i32 s9, 960
buffer_load_dwordx4 v248, s[44:47], s9 offen lds
s_mul_i32 s8, s3, 20480
s_add_u32 m0, s8, 16384
s_movk_i32 s9, 1024
buffer_load_dwordx4 v248, s[44:47], s9 offen lds
s_mul_i32 s8, s3, 20480
s_add_u32 m0, s8, 17408
s_movk_i32 s9, 1088
buffer_load_dwordx4 v248, s[44:47], s9 offen lds
s_mul_i32 s8, s3, 20480
s_add_u32 m0, s8, 18432
s_movk_i32 s9, 1152
buffer_load_dwordx4 v248, s[44:47], s9 offen lds
s_mul_i32 s8, s3, 20480
s_add_u32 m0, s8, 19456
s_movk_i32 s9, 1216
buffer_load_dwordx4 v248, s[44:47], s9 offen lds
s_add_u32 s8, s13, s14
s_add_u32 m0, s8, 0
s_nop 0
buffer_load_dwordx4 v192, s[48:51], s10 offen lds
s_add_u32 s8, s13, s14
s_add_u32 m0, s8, 1024
s_nop 0
buffer_load_dwordx4 v193, s[48:51], s10 offen lds
s_add_u32 s8, s13, s14
s_add_u32 m0, s8, 2048
s_nop 0
buffer_load_dwordx4 v194, s[48:51], s10 offen lds
s_add_u32 s8, s13, s14
s_add_u32 m0, s8, 3072
s_nop 0
buffer_load_dwordx4 v195, s[48:51], s10 offen lds
s_add_u32 s8, s13, s14
s_add_u32 m0, s8, 4096
s_nop 0
buffer_load_dwordx4 v196, s[48:51], s10 offen lds
s_add_u32 s10, s10, 163840
s_add_u32 s14, s14, 20480
s_cmp_ge_u32 s14, 61440
s_cselect_b32 s14, 0, s14
s_add_u32 s8, s13, s14
s_add_u32 m0, s8, 0
s_nop 0
buffer_load_dwordx4 v192, s[48:51], s10 offen lds
s_add_u32 s8, s13, s14
s_add_u32 m0, s8, 1024
s_nop 0
buffer_load_dwordx4 v193, s[48:51], s10 offen lds
s_add_u32 s8, s13, s14
s_add_u32 m0, s8, 2048
s_nop 0
buffer_load_dwordx4 v194, s[48:51], s10 offen lds
s_add_u32 s8, s13, s14
s_add_u32 m0, s8, 3072
s_nop 0
buffer_load_dwordx4 v195, s[48:51], s10 offen lds
s_add_u32 s8, s13, s14
s_add_u32 m0, s8, 4096
s_nop 0
buffer_load_dwordx4 v196, s[48:51], s10 offen lds
s_add_u32 s10, s10, 163840
s_add_u32 s14, s14, 20480
s_cmp_ge_u32 s14, 61440
s_cselect_b32 s14, 0, s14
v_mov_b32 v240, 0
v_mov_b32 v241, 0
s_waitcnt vmcnt(10)
s_waitcnt lgkmcnt(0)
v_and_b32 v240, 1, v254
v_lshrrev_b32 v241, 2, v253
v_and_b32 v242, 3, v253
v_lshlrev_b32 v242, 3, v242
v_add_u32 v242, 81920, v242
v_mov_b32 v243, 0
v_lshl_add_u32 v243, v254, 3, v243
v_add_u32 v243, v243, v241
s_movk_i32 s9, 160
v_mad_u32_u24 v244, v243, s9, v242
v_mov_b32 v243, 4
v_lshl_add_u32 v243, v254, 3, v243
v_add_u32 v243, v243, v241
s_movk_i32 s9, 160
v_mad_u32_u24 v245, v243, s9, v242
s_mov_b32 s15, 0
s_mov_b32 s12, 0
k2_kernel_L:
s_waitcnt vmcnt(5)
s_barrier
s_add_u32 s8, s13, s14
s_add_u32 m0, s8, 0
s_nop 0
buffer_load_dwordx4 v192, s[48:51], s10 offen lds
s_add_u32 s8, s13, s14
s_add_u32 m0, s8, 1024
s_nop 0
buffer_load_dwordx4 v193, s[48:51], s10 offen lds
s_add_u32 s8, s13, s14
s_add_u32 m0, s8, 2048
s_nop 0
buffer_load_dwordx4 v194, s[48:51], s10 offen lds
s_add_u32 s8, s13, s14
s_add_u32 m0, s8, 3072
s_nop 0
buffer_load_dwordx4 v195, s[48:51], s10 offen lds
s_add_u32 s8, s13, s14
s_add_u32 m0, s8, 4096
s_nop 0
buffer_load_dwordx4 v196, s[48:51], s10 offen lds
s_add_u32 s10, s10, 163840
s_add_u32 s14, s14, 20480
s_cmp_ge_u32 s14, 61440
s_cselect_b32 s14, 0, s14
v_add_u32 v246, s15, v244
v_add_u32 v247, s15, v245
v_add_u32 v237, s12, v236
ds_read_b128 v[32:35], v237 offset:0
ds_read_b128 v[36:39], v237 offset:1024
ds_read_b128 v[40:43], v237 offset:2048
ds_read_b128 v[44:47], v237 offset:3072
ds_read_b64_tr_b16 v[144:145], v246 offset:0
ds_read_b64_tr_b16 v[146:147], v247 offset:0
ds_read_b64_tr_b16 v[148:149], v246 offset:32
ds_read_b64_tr_b16 v[150:151], v247 offset:32
ds_read_b64_tr_b16 v[152:153], v246 offset:64
ds_read_b64_tr_b16 v[154:155], v247 offset:64
ds_read_b64_tr_b16 v[156:157], v246 offset:96
ds_read_b64_tr_b16 v[158:159], v247 offset:96
ds_read_b64_tr_b16 v[160:161], v246 offset:128
ds_read_b64_tr_b16 v[162:163], v247 offset:128
ds_read_b64_tr_b16 v[164:165], v246 offset:5120
ds_read_b64_tr_b16 v[166:167], v247 offset:5120
s_waitcnt lgkmcnt(10)
v_mfma_f32_16x16x32_bf16 a[0:3], v[144:147], v[32:35], a[0:3]
ds_read_b64_tr_b16 v[168:169], v246 offset:5152
ds_read_b64_tr_b16 v[170:171], v247 offset:5152
s_waitcnt lgkmcnt(10)
v_mfma_f32_16x16x32_bf16 a[4:7], v[148:151], v[32:35], a[4:7]
ds_read_b64_tr_b16 v[144:145], v246 offset:5184
ds_read_b64_tr_b16 v[146:147], v247 offset:5184
s_waitcnt lgkmcnt(10)
v_mfma_f32_16x16x32_bf16 a[8:11], v[152:155], v[32:35], a[8:11]
ds_read_b64_tr_b16 v[148:149], v246 offset:5216
ds_read_b64_tr_b16 v[150:151], v247 offset:5216
s_waitcnt lgkmcnt(10)
v_mfma_f32_16x16x32_bf16 a[12:15], v[156:159], v[32:35], a[12:15]
ds_read_b64_tr_b16 v[152:153], v246 offset:5248
ds_read_b64_tr_b16 v[154:155], v247 offset:5248
s_waitcnt lgkmcnt(10)
v_mfma_f32_16x16x32_bf16 a[16:19], v[160:163], v[32:35], a[16:19]
ds_read_b64_tr_b16 v[156:157], v246 offset:10240
ds_read_b64_tr_b16 v[158:159], v247 offset:10240
s_waitcnt lgkmcnt(10)
v_mfma_f32_16x16x32_bf16 a[0:3], v[164:167], v[36:39], a[0:3]
ds_read_b64_tr_b16 v[160:161], v246 offset:10272
ds_read_b64_tr_b16 v[162:163], v247 offset:10272
s_waitcnt lgkmcnt(10)
v_mfma_f32_16x16x32_bf16 a[4:7], v[168:171], v[36:39], a[4:7]
ds_read_b64_tr_b16 v[164:165], v246 offset:10304
ds_read_b64_tr_b16 v[166:167], v247 offset:10304
s_waitcnt lgkmcnt(10)
v_mfma_f32_16x16x32_bf16 a[8:11], v[144:147], v[36:39], a[8:11]
ds_read_b64_tr_b16 v[168:169], v246 offset:10336
ds_read_b64_tr_b16 v[170:171], v247 offset:10336
s_waitcnt lgkmcnt(10)
v_mfma_f32_16x16x32_bf16 a[12:15], v[148:151], v[36:39], a[12:15]
ds_read_b64_tr_b16 v[144:145], v246 offset:10368
ds_read_b64_tr_b16 v[146:147], v247 offset:10368
s_waitcnt lgkmcnt(10)
v_mfma_f32_16x16x32_bf16 a[16:19], v[152:155], v[36:39], a[16:19]
ds_read_b64_tr_b16 v[148:149], v246 offset:15360
ds_read_b64_tr_b16 v[150:151], v247 offset:15360
s_waitcnt lgkmcnt(10)
v_mfma_f32_16x16x32_bf16 a[0:3], v[156:159], v[40:43], a[0:3]
ds_read_b64_tr_b16 v[152:153], v246 offset:15392
ds_read_b64_tr_b16 v[154:155], v247 offset:15392
s_waitcnt lgkmcnt(10)
v_mfma_f32_16x16x32_bf16 a[4:7], v[160:163], v[40:43], a[4:7]
ds_read_b64_tr_b16 v[156:157], v246 offset:15424
ds_read_b64_tr_b16 v[158:159], v247 offset:15424
s_waitcnt lgkmcnt(10)
v_mfma_f32_16x16x32_bf16 a[8:11], v[164:167], v[40:43], a[8:11]
ds_read_b64_tr_b16 v[160:161], v246 offset:15456
ds_read_b64_tr_b16 v[162:163], v247 offset:15456
s_waitcnt lgkmcnt(10)
v_mfma_f32_16x16x32_bf16 a[12:15], v[168:171], v[40:43], a[12:15]
ds_read_b64_tr_b16 v[164:165], v246 offset:15488
ds_read_b64_tr_b16 v[166:167], v247 offset:15488
s_waitcnt lgkmcnt(10)
v_mfma_f32_16x16x32_bf16 a[16:19], v[144:147], v[40:43], a[16:19]
s_waitcnt lgkmcnt(8)
v_mfma_f32_16x16x32_bf16 a[0:3], v[148:151], v[44:47], a[0:3]
s_waitcnt lgkmcnt(6)
v_mfma_f32_16x16x32_bf16 a[4:7], v[152:155], v[44:47], a[4:7]
s_waitcnt lgkmcnt(4)
v_mfma_f32_16x16x32_bf16 a[8:11], v[156:159], v[44:47], a[8:11]
s_waitcnt lgkmcnt(2)
v_mfma_f32_16x16x32_bf16 a[12:15], v[160:163], v[44:47], a[12:15]
s_waitcnt lgkmcnt(0)
v_mfma_f32_16x16x32_bf16 a[16:19], v[164:167], v[44:47], a[16:19]
s_add_u32 s15, s15, 20480
s_cmp_ge_u32 s15, 61440
s_cselect_b32 s15, 0, s15
s_add_u32 s12, s12, 4096
s_cmp_lt_u32 s12, 20480
s_cbranch_scc1 k2_kernel_L
s_waitcnt vmcnt(0)
s_nop 7
s_nop 7
s_mul_i32 s10, s5, 160
v_lshlrev_b32 v241, 3, v254
v_add_u32 v241, s10, v241
s_movk_i32 s9, 1280
v_mad_u32_u24 v240, v255, s9, v241
s_add_u32 s52, s36, 5242880
s_addc_u32 s53, s37, 0
s_mov_b32 s54, 2621440
s_mov_b32 s55, 0x00020000
s_mov_b32 s56, s16
s_mov_b32 s57, s17
s_mov_b32 s58, 2621440
s_mov_b32 s59, 0x00020000
v_accvgpr_read_b32 v228, a64
v_accvgpr_read_b32 v229, a65
v_accvgpr_read_b32 v224, a0
v_cvt_pk_bf16_f32 v224, v224, v224
v_and_b32 v224, 0xffff0000, v224
v_accvgpr_read_b32 v225, a1
v_cvt_pk_bf16_f32 v225, v225, v225
v_and_b32 v225, 0xffff0000, v225
v_accvgpr_read_b32 v226, a2
v_cvt_pk_bf16_f32 v226, v226, v226
v_and_b32 v226, 0xffff0000, v226
v_accvgpr_read_b32 v227, a3
v_cvt_pk_bf16_f32 v227, v227, v227
v_and_b32 v227, 0xffff0000, v227
v_lshlrev_b32 v232, 16, v228
v_and_b32 v233, 0xffff0000, v228
v_add_f32 v224, v224, v232
v_add_f32 v225, v225, v233
v_lshlrev_b32 v232, 16, v229
v_and_b32 v233, 0xffff0000, v229
v_add_f32 v226, v226, v232
v_add_f32 v227, v227, v233
v_cvt_pk_bf16_f32 v224, v224, v225
v_cvt_pk_bf16_f32 v225, v226, v227
buffer_store_dwordx2 v[224:225], v240, s[52:55], 0 offen offset:0
s_nop 1
v_accvgpr_read_b32 v228, a66
v_accvgpr_read_b32 v229, a67
v_accvgpr_read_b32 v224, a4
v_cvt_pk_bf16_f32 v224, v224, v224
v_and_b32 v224, 0xffff0000, v224
v_accvgpr_read_b32 v225, a5
v_cvt_pk_bf16_f32 v225, v225, v225
v_and_b32 v225, 0xffff0000, v225
v_accvgpr_read_b32 v226, a6
v_cvt_pk_bf16_f32 v226, v226, v226
v_and_b32 v226, 0xffff0000, v226
v_accvgpr_read_b32 v227, a7
v_cvt_pk_bf16_f32 v227, v227, v227
v_and_b32 v227, 0xffff0000, v227
v_lshlrev_b32 v232, 16, v228
v_and_b32 v233, 0xffff0000, v228
v_add_f32 v224, v224, v232
v_add_f32 v225, v225, v233
v_lshlrev_b32 v232, 16, v229
v_and_b32 v233, 0xffff0000, v229
v_add_f32 v226, v226, v232
v_add_f32 v227, v227, v233
v_cvt_pk_bf16_f32 v224, v224, v225
v_cvt_pk_bf16_f32 v225, v226, v227
buffer_store_dwordx2 v[224:225], v240, s[52:55], 0 offen offset:32
s_nop 1
v_accvgpr_read_b32 v228, a68
v_accvgpr_read_b32 v229, a69
v_accvgpr_read_b32 v224, a8
v_cvt_pk_bf16_f32 v224, v224, v224
v_and_b32 v224, 0xffff0000, v224
v_accvgpr_read_b32 v225, a9
v_cvt_pk_bf16_f32 v225, v225, v225
v_and_b32 v225, 0xffff0000, v225
v_accvgpr_read_b32 v226, a10
v_cvt_pk_bf16_f32 v226, v226, v226
v_and_b32 v226, 0xffff0000, v226
v_accvgpr_read_b32 v227, a11
v_cvt_pk_bf16_f32 v227, v227, v227
v_and_b32 v227, 0xffff0000, v227
v_lshlrev_b32 v232, 16, v228
v_and_b32 v233, 0xffff0000, v228
v_add_f32 v224, v224, v232
v_add_f32 v225, v225, v233
v_lshlrev_b32 v232, 16, v229
v_and_b32 v233, 0xffff0000, v229
v_add_f32 v226, v226, v232
v_add_f32 v227, v227, v233
v_cvt_pk_bf16_f32 v224, v224, v225
v_cvt_pk_bf16_f32 v225, v226, v227
buffer_store_dwordx2 v[224:225], v240, s[52:55], 0 offen offset:64
s_nop 1
v_accvgpr_read_b32 v228, a70
v_accvgpr_read_b32 v229, a71
v_accvgpr_read_b32 v224, a12
v_cvt_pk_bf16_f32 v224, v224, v224
v_and_b32 v224, 0xffff0000, v224
v_accvgpr_read_b32 v225, a13
v_cvt_pk_bf16_f32 v225, v225, v225
v_and_b32 v225, 0xffff0000, v225
v_accvgpr_read_b32 v226, a14
v_cvt_pk_bf16_f32 v226, v226, v226
v_and_b32 v226, 0xffff0000, v226
v_accvgpr_read_b32 v227, a15
v_cvt_pk_bf16_f32 v227, v227, v227
v_and_b32 v227, 0xffff0000, v227
v_lshlrev_b32 v232, 16, v228
v_and_b32 v233, 0xffff0000, v228
v_add_f32 v224, v224, v232
v_add_f32 v225, v225, v233
v_lshlrev_b32 v232, 16, v229
v_and_b32 v233, 0xffff0000, v229
v_add_f32 v226, v226, v232
v_add_f32 v227, v227, v233
v_cvt_pk_bf16_f32 v224, v224, v225
v_cvt_pk_bf16_f32 v225, v226, v227
buffer_store_dwordx2 v[224:225], v240, s[52:55], 0 offen offset:96
s_nop 1
v_accvgpr_read_b32 v228, a72
v_accvgpr_read_b32 v229, a73
v_accvgpr_read_b32 v224, a16
v_cvt_pk_bf16_f32 v224, v224, v224
v_and_b32 v224, 0xffff0000, v224
v_accvgpr_read_b32 v225, a17
v_cvt_pk_bf16_f32 v225, v225, v225
v_and_b32 v225, 0xffff0000, v225
v_accvgpr_read_b32 v226, a18
v_cvt_pk_bf16_f32 v226, v226, v226
v_and_b32 v226, 0xffff0000, v226
v_accvgpr_read_b32 v227, a19
v_cvt_pk_bf16_f32 v227, v227, v227
v_and_b32 v227, 0xffff0000, v227
v_lshlrev_b32 v232, 16, v228
v_and_b32 v233, 0xffff0000, v228
v_add_f32 v224, v224, v232
v_add_f32 v225, v225, v233
v_lshlrev_b32 v232, 16, v229
v_and_b32 v233, 0xffff0000, v229
v_add_f32 v226, v226, v232
v_add_f32 v227, v227, v233
v_cvt_pk_bf16_f32 v224, v224, v225
v_cvt_pk_bf16_f32 v225, v226, v227
buffer_store_dwordx2 v[224:225], v240, s[52:55], 0 offen offset:128
s_nop 1
k2_kernel_end:
s_endpgm
.p2align 8
.globl k3_kernel
.type k3_kernel,@function
k3_kernel:
s_cmp_ge_u32 s2, 256
s_cbranch_scc1 k3_kernel_end
s_load_dwordx16 s[16:31], s[0:1], 0
s_load_dwordx4 s[32:35], s[0:1], 64
s_load_dwordx2 s[36:37], s[0:1], 80
s_mov_b32 s40, 0x3d372713
s_mov_b32 s41, 0xc0135761
s_mov_b32 s42, 0x3acccccd
v_and_b32 v252, 63, v0
v_lshrrev_b32 v253, 6, v0
s_nop 0
v_readfirstlane_b32 s3, v253
v_and_b32 v253, 15, v252
v_lshrrev_b32 v254, 4, v252
v_xor_b32 v250, 16, v252
v_lshlrev_b32 v250, 2, v250
v_xor_b32 v251, 32, v252
v_lshlrev_b32 v251, 2, v251
s_and_b32 s4, s2, 7
s_lshl_b32 s4, s4, 2
s_lshr_b32 s5, s2, 3
s_and_b32 s6, s5, 3
s_add_u32 s4, s4, s6
s_lshr_b32 s5, s5, 2
s_lshl_b32 s6, s4, 6
s_lshl_b32 s7, s3, 4
s_add_u32 s6, s6, s7
v_add_u32 v255, s6, v253
s_waitcnt lgkmcnt(0)
s_add_u32 s44, s36, 5242880
s_addc_u32 s45, s37, 0
s_mov_b32 s46, 2621440
s_mov_b32 s47, 0x00020000
s_mov_b32 s48, s24
s_mov_b32 s49, s25
s_mov_b32 s50, 819200
s_mov_b32 s51, 0x00020000
s_mul_i32 s8, s3, 5120
v_lshlrev_b32 v240, 4, v252
v_add_u32 v240, s8, v240
v_add_u32 v240, 0, v240
v_cvt_f32_u32 v241, v240
s_mov_b32 s9, 0x3bcccccd
v_add_f32 v241, 0.5, v241
v_mul_f32 v241, s9, v241
v_cvt_u32_f32 v241, v241
s_movk_i32 s9, 160
v_mul_lo_u32 v242, v241, s9
v_sub_u32 v242, v240, v242
s_movk_i32 s9, 1280
v_mad_u32_u24 v192, v241, s9, v242
s_mul_i32 s8, s3, 5120
v_lshlrev_b32 v240, 4, v252
v_add_u32 v240, s8, v240
v_add_u32 v240, 1024, v240
v_cvt_f32_u32 v241, v240
s_mov_b32 s9, 0x3bcccccd
v_add_f32 v241, 0.5, v241
v_mul_f32 v241, s9, v241
v_cvt_u32_f32 v241, v241
s_movk_i32 s9, 160
v_mul_lo_u32 v242, v241, s9
v_sub_u32 v242, v240, v242
s_movk_i32 s9, 1280
v_mad_u32_u24 v193, v241, s9, v242
s_mul_i32 s8, s3, 5120
v_lshlrev_b32 v240, 4, v252
v_add_u32 v240, s8, v240
v_add_u32 v240, 2048, v240
v_cvt_f32_u32 v241, v240
s_mov_b32 s9, 0x3bcccccd
v_add_f32 v241, 0.5, v241
v_mul_f32 v241, s9, v241
v_cvt_u32_f32 v241, v241
s_movk_i32 s9, 160
v_mul_lo_u32 v242, v241, s9
v_sub_u32 v242, v240, v242
s_movk_i32 s9, 1280
v_mad_u32_u24 v194, v241, s9, v242
s_mul_i32 s8, s3, 5120
v_lshlrev_b32 v240, 4, v252
v_add_u32 v240, s8, v240
v_add_u32 v240, 3072, v240
v_cvt_f32_u32 v241, v240
s_mov_b32 s9, 0x3bcccccd
v_add_f32 v241, 0.5, v241
v_mul_f32 v241, s9, v241
v_cvt_u32_f32 v241, v241
s_movk_i32 s9, 160
v_mul_lo_u32 v242, v241, s9
v_sub_u32 v242, v240, v242
s_movk_i32 s9, 1280
v_mad_u32_u24 v195, v241, s9, v242
s_mul_i32 s8, s3, 5120
v_lshlrev_b32 v240, 4, v252
v_add_u32 v240, s8, v240
v_add_u32 v240, 4096, v240
v_cvt_f32_u32 v241, v240
s_mov_b32 s9, 0x3bcccccd
v_add_f32 v241, 0.5, v241
v_mul_f32 v241, s9, v241
v_cvt_u32_f32 v241, v241
s_movk_i32 s9, 160
v_mul_lo_u32 v242, v241, s9
v_sub_u32 v242, v240, v242
s_movk_i32 s9, 1280
v_mad_u32_u24 v196, v241, s9, v242
s_mul_i32 s10, s5, 160
s_mul_i32 s13, s3, 5120
s_add_u32 s13, s13, 81920
s_mov_b32 s14, 0
v_and_b32 v240, 1, v254
v_mov_b32 v241, 0
v_lshl_add_u32 v241, v254, 4, v241
s_movk_i32 s9, 1280
v_mad_u32_u24 v248, v255, s9, v241
v_mov_b32 v241, 8
v_lshl_add_u32 v241, v254, 4, v241
s_movk_i32 s9, 1280
v_mad_u32_u24 v249, v255, s9, v241
v_accvgpr_write_b32 a0, 0
v_accvgpr_write_b32 a1, 0
v_accvgpr_write_b32 a2, 0
v_accvgpr_write_b32 a3, 0
v_accvgpr_write_b32 a4, 0
v_accvgpr_write_b32 a5, 0
v_accvgpr_write_b32 a6, 0
v_accvgpr_write_b32 a7, 0
v_accvgpr_write_b32 a8, 0
v_accvgpr_write_b32 a9, 0
v_accvgpr_write_b32 a10, 0
v_accvgpr_write_b32 a11, 0
v_accvgpr_write_b32 a12, 0
v_accvgpr_write_b32 a13, 0
v_accvgpr_write_b32 a14, 0
v_accvgpr_write_b32 a15, 0
v_accvgpr_write_b32 a16, 0
v_accvgpr_write_b32 a17, 0
v_accvgpr_write_b32 a18, 0
v_accvgpr_write_b32 a19, 0
v_lshlrev_b32 v236, 4, v252
s_mul_i32 s8, s3, 20480
v_add_u32 v236, s8, v236
s_mul_i32 s8, s3, 20480
s_add_u32 m0, s8, 0
s_movk_i32 s9, 0
buffer_load_dwordx4 v248, s[44:47], s9 offen lds
s_mul_i32 s8, s3, 20480
s_add_u32 m0, s8, 1024
s_movk_i32 s9, 64
buffer_load_dwordx4 v248, s[44:47], s9 offen lds
s_mul_i32 s8, s3, 20480
s_add_u32 m0, s8, 2048
s_movk_i32 s9, 128
buffer_load_dwordx4 v248, s[44:47], s9 offen lds
s_mul_i32 s8, s3, 20480
s_add_u32 m0, s8, 3072
s_movk_i32 s9, 192
buffer_load_dwordx4 v248, s[44:47], s9 offen lds
s_mul_i32 s8, s3, 20480
s_add_u32 m0, s8, 4096
s_movk_i32 s9, 256
buffer_load_dwordx4 v248, s[44:47], s9 offen lds
s_mul_i32 s8, s3, 20480
s_add_u32 m0, s8, 5120
s_movk_i32 s9, 320
buffer_load_dwordx4 v248, s[44:47], s9 offen lds
s_mul_i32 s8, s3, 20480
s_add_u32 m0, s8, 6144
s_movk_i32 s9, 384
buffer_load_dwordx4 v248, s[44:47], s9 offen lds
s_mul_i32 s8, s3, 20480
s_add_u32 m0, s8, 7168
s_movk_i32 s9, 448
buffer_load_dwordx4 v248, s[44:47], s9 offen lds
s_mul_i32 s8, s3, 20480
s_add_u32 m0, s8, 8192
s_movk_i32 s9, 512
buffer_load_dwordx4 v248, s[44:47], s9 offen lds
s_mul_i32 s8, s3, 20480
s_add_u32 m0, s8, 9216
s_movk_i32 s9, 576
buffer_load_dwordx4 v248, s[44:47], s9 offen lds
s_mul_i32 s8, s3, 20480
s_add_u32 m0, s8, 10240
s_movk_i32 s9, 640
buffer_load_dwordx4 v248, s[44:47], s9 offen lds
s_mul_i32 s8, s3, 20480
s_add_u32 m0, s8, 11264
s_movk_i32 s9, 704
buffer_load_dwordx4 v248, s[44:47], s9 offen lds
s_mul_i32 s8, s3, 20480
s_add_u32 m0, s8, 12288
s_movk_i32 s9, 768
buffer_load_dwordx4 v248, s[44:47], s9 offen lds
s_mul_i32 s8, s3, 20480
s_add_u32 m0, s8, 13312
s_movk_i32 s9, 832
buffer_load_dwordx4 v248, s[44:47], s9 offen lds
s_mul_i32 s8, s3, 20480
s_add_u32 m0, s8, 14336
s_movk_i32 s9, 896
buffer_load_dwordx4 v248, s[44:47], s9 offen lds
s_mul_i32 s8, s3, 20480
s_add_u32 m0, s8, 15360
s_movk_i32 s9, 960
buffer_load_dwordx4 v248, s[44:47], s9 offen lds
s_mul_i32 s8, s3, 20480
s_add_u32 m0, s8, 16384
s_movk_i32 s9, 1024
buffer_load_dwordx4 v248, s[44:47], s9 offen lds
s_mul_i32 s8, s3, 20480
s_add_u32 m0, s8, 17408
s_movk_i32 s9, 1088
buffer_load_dwordx4 v248, s[44:47], s9 offen lds
s_mul_i32 s8, s3, 20480
s_add_u32 m0, s8, 18432
s_movk_i32 s9, 1152
buffer_load_dwordx4 v248, s[44:47], s9 offen lds
s_mul_i32 s8, s3, 20480
s_add_u32 m0, s8, 19456
s_movk_i32 s9, 1216
buffer_load_dwordx4 v248, s[44:47], s9 offen lds
s_add_u32 s8, s13, s14
s_add_u32 m0, s8, 0
s_nop 0
buffer_load_dwordx4 v192, s[48:51], s10 offen lds
s_add_u32 s8, s13, s14
s_add_u32 m0, s8, 1024
s_nop 0
buffer_load_dwordx4 v193, s[48:51], s10 offen lds
s_add_u32 s8, s13, s14
s_add_u32 m0, s8, 2048
s_nop 0
buffer_load_dwordx4 v194, s[48:51], s10 offen lds
s_add_u32 s8, s13, s14
s_add_u32 m0, s8, 3072
s_nop 0
buffer_load_dwordx4 v195, s[48:51], s10 offen lds
s_add_u32 s8, s13, s14
s_add_u32 m0, s8, 4096
s_nop 0
buffer_load_dwordx4 v196, s[48:51], s10 offen lds
s_add_u32 s10, s10, 163840
s_add_u32 s14, s14, 20480
s_cmp_ge_u32 s14, 61440
s_cselect_b32 s14, 0, s14
s_add_u32 s8, s13, s14
s_add_u32 m0, s8, 0
s_nop 0
buffer_load_dwordx4 v192, s[48:51], s10 offen lds
s_add_u32 s8, s13, s14
s_add_u32 m0, s8, 1024
s_nop 0
buffer_load_dwordx4 v193, s[48:51], s10 offen lds
s_add_u32 s8, s13, s14
s_add_u32 m0, s8, 2048
s_nop 0
buffer_load_dwordx4 v194, s[48:51], s10 offen lds
s_add_u32 s8, s13, s14
s_add_u32 m0, s8, 3072
s_nop 0
buffer_load_dwordx4 v195, s[48:51], s10 offen lds
s_add_u32 s8, s13, s14
s_add_u32 m0, s8, 4096
s_nop 0
buffer_load_dwordx4 v196, s[48:51], s10 offen lds
s_add_u32 s10, s10, 163840
s_add_u32 s14, s14, 20480
s_cmp_ge_u32 s14, 61440
s_cselect_b32 s14, 0, s14
v_mov_b32 v240, 0
v_mov_b32 v241, 0
s_waitcnt vmcnt(10)
s_waitcnt lgkmcnt(0)
s_add_u32 s52, s36, 7864320
s_addc_u32 s53, s37, 0
s_mov_b32 s54, 2621440
s_mov_b32 s55, 0x00020000
s_cmp_eq_u32 s5, 0
s_cselect_b32 s54, s54, 0
v_mov_b32 v240, 0
v_mov_b32 v241, 0
s_mov_b32 s9, 0
k3_kernel_axs:
v_add_u32 v237, s9, v236
ds_read_b128 v[0:3], v237 offset:0
ds_read_b128 v[4:7], v237 offset:1024
ds_read_b128 v[8:11], v237 offset:2048
ds_read_b128 v[12:15], v237 offset:3072
s_waitcnt lgkmcnt(0)
v_lshlrev_b32 v242, 16, v0
v_and_b32 v243, 0xffff0000, v0
v_add_f32 v240, v240, v242
v_add_f32 v240, v240, v243
v_fmac_f32 v241, v242, v242
v_fmac_f32 v241, v243, v243
v_lshlrev_b32 v242, 16, v1
v_and_b32 v243, 0xffff0000, v1
v_add_f32 v240, v240, v242
v_add_f32 v240, v240, v243
v_fmac_f32 v241, v242, v242
v_fmac_f32 v241, v243, v243
v_lshlrev_b32 v242, 16, v2
v_and_b32 v243, 0xffff0000, v2
v_add_f32 v240, v240, v242
v_add_f32 v240, v240, v243
v_fmac_f32 v241, v242, v242
v_fmac_f32 v241, v243, v243
v_lshlrev_b32 v242, 16, v3
v_and_b32 v243, 0xffff0000, v3
v_add_f32 v240, v240, v242
v_add_f32 v240, v240, v243
v_fmac_f32 v241, v242, v242
v_fmac_f32 v241, v243, v243
v_lshlrev_b32 v242, 16, v4
v_and_b32 v243, 0xffff0000, v4
v_add_f32 v240, v240, v242
v_add_f32 v240, v240, v243
v_fmac_f32 v241, v242, v242
v_fmac_f32 v241, v243, v243
v_lshlrev_b32 v242, 16, v5
v_and_b32 v243, 0xffff0000, v5
v_add_f32 v240, v240, v242
v_add_f32 v240, v240, v243
v_fmac_f32 v241, v242, v242
v_fmac_f32 v241, v243, v243
v_lshlrev_b32 v242, 16, v6
v_and_b32 v243, 0xffff0000, v6
v_add_f32 v240, v240, v242
v_add_f32 v240, v240, v243
v_fmac_f32 v241, v242, v242
v_fmac_f32 v241, v243, v243
v_lshlrev_b32 v242, 16, v7
v_and_b32 v243, 0xffff0000, v7
v_add_f32 v240, v240, v242
v_add_f32 v240, v240, v243
v_fmac_f32 v241, v242, v242
v_fmac_f32 v241, v243, v243
v_lshlrev_b32 v242, 16, v8
v_and_b32 v243, 0xffff0000, v8
v_add_f32 v240, v240, v242
v_add_f32 v240, v240, v243
v_fmac_f32 v241, v242, v242
v_fmac_f32 v241, v243, v243
v_lshlrev_b32 v242, 16, v9
v_and_b32 v243, 0xffff0000, v9
v_add_f32 v240, v240, v242
v_add_f32 v240, v240, v243
v_fmac_f32 v241, v242, v242
v_fmac_f32 v241, v243, v243
v_lshlrev_b32 v242, 16, v10
v_and_b32 v243, 0xffff0000, v10
v_add_f32 v240, v240, v242
v_add_f32 v240, v240, v243
v_fmac_f32 v241, v242, v242
v_fmac_f32 v241, v243, v243
v_lshlrev_b32 v242, 16, v11
v_and_b32 v243, 0xffff0000, v11
v_add_f32 v240, v240, v242
v_add_f32 v240, v240, v243
v_fmac_f32 v241, v242, v242
v_fmac_f32 v241, v243, v243
v_lshlrev_b32 v242, 16, v12
v_and_b32 v243, 0xffff0000, v12
v_add_f32 v240, v240, v242
v_add_f32 v240, v240, v243
v_fmac_f32 v241, v242, v242
v_fmac_f32 v241, v243, v243
v_lshlrev_b32 v242, 16, v13
v_and_b32 v243, 0xffff0000, v13
v_add_f32 v240, v240, v242
v_add_f32 v240, v240, v243
v_fmac_f32 v241, v242, v242
v_fmac_f32 v241, v243, v243
v_lshlrev_b32 v242, 16, v14
v_and_b32 v243, 0xffff0000, v14
v_add_f32 v240, v240, v242
v_add_f32 v240, v240, v243
v_fmac_f32 v241, v242, v242
v_fmac_f32 v241, v243, v243
v_lshlrev_b32 v242, 16, v15
v_and_b32 v243, 0xffff0000, v15
v_add_f32 v240, v240, v242
v_add_f32 v240, v240, v243
v_fmac_f32 v241, v242, v242
v_fmac_f32 v241, v243, v243
s_add_u32 s9, s9, 4096
s_cmp_lt_u32 s9, 20480
s_cbranch_scc1 k3_kernel_axs
ds_bpermute_b32 v244, v250, v240
s_waitcnt lgkmcnt(0)
v_add_f32 v240, v240, v244
ds_bpermute_b32 v244, v251, v240
s_waitcnt lgkmcnt(0)
v_add_f32 v240, v240, v244
ds_bpermute_b32 v244, v250, v241
s_waitcnt lgkmcnt(0)
v_add_f32 v241, v241, v244
ds_bpermute_b32 v244, v251, v241
s_waitcnt lgkmcnt(0)
v_add_f32 v241, v241, v244
v_mul_f32 v240, s42, v240
v_mul_f32 v241, s42, v241
v_fma_f32 v241, -v240, v240, v241
v_max_f32 v241, 0, v241
v_cvt_pk_bf16_f32 v240, v240, v240
v_and_b32 v240, 0xffff0000, v240
v_cvt_pk_bf16_f32 v241, v241, v241
v_and_b32 v241, 0xffff0000, v241
v_add_f32 v241, 0x3727c5ac, v241
v_cvt_pk_bf16_f32 v241, v241, v241
v_and_b32 v241, 0xffff0000, v241
v_sqrt_f32 v241, v241
s_nop 0
v_cvt_pk_bf16_f32 v241, v241, v241
v_and_b32 v241, 0xffff0000, v241
v_rcp_f32 v241, v241
s_mov_b32 s9, 0
k3_kernel_axn:
v_add_u32 v237, s9, v236
ds_read_b128 v[0:3], v237 offset:0
ds_read_b128 v[4:7], v237 offset:1024
ds_read_b128 v[8:11], v237 offset:2048
ds_read_b128 v[12:15], v237 offset:3072
s_waitcnt lgkmcnt(0)
v_lshlrev_b32 v242, 16, v0
v_and_b32 v243, 0xffff0000, v0
v_sub_f32 v242, v242, v240
v_sub_f32 v243, v243, v240
v_cvt_pk_bf16_f32 v244, v242, v243
v_lshlrev_b32 v242, 16, v244
v_and_b32 v243, 0xffff0000, v244
v_mul_f32 v242, v242, v241
v_mul_f32 v243, v243, v241
v_cvt_pk_bf16_f32 v0, v242, v243
v_lshlrev_b32 v242, 16, v1
v_and_b32 v243, 0xffff0000, v1
v_sub_f32 v242, v242, v240
v_sub_f32 v243, v243, v240
v_cvt_pk_bf16_f32 v244, v242, v243
v_lshlrev_b32 v242, 16, v244
v_and_b32 v243, 0xffff0000, v244
v_mul_f32 v242, v242, v241
v_mul_f32 v243, v243, v241
v_cvt_pk_bf16_f32 v1, v242, v243
v_lshlrev_b32 v242, 16, v2
v_and_b32 v243, 0xffff0000, v2
v_sub_f32 v242, v242, v240
v_sub_f32 v243, v243, v240
v_cvt_pk_bf16_f32 v244, v242, v243
v_lshlrev_b32 v242, 16, v244
v_and_b32 v243, 0xffff0000, v244
v_mul_f32 v242, v242, v241
v_mul_f32 v243, v243, v241
v_cvt_pk_bf16_f32 v2, v242, v243
v_lshlrev_b32 v242, 16, v3
v_and_b32 v243, 0xffff0000, v3
v_sub_f32 v242, v242, v240
v_sub_f32 v243, v243, v240
v_cvt_pk_bf16_f32 v244, v242, v243
v_lshlrev_b32 v242, 16, v244
v_and_b32 v243, 0xffff0000, v244
v_mul_f32 v242, v242, v241
v_mul_f32 v243, v243, v241
v_cvt_pk_bf16_f32 v3, v242, v243
v_lshlrev_b32 v242, 16, v4
v_and_b32 v243, 0xffff0000, v4
v_sub_f32 v242, v242, v240
v_sub_f32 v243, v243, v240
v_cvt_pk_bf16_f32 v244, v242, v243
v_lshlrev_b32 v242, 16, v244
v_and_b32 v243, 0xffff0000, v244
v_mul_f32 v242, v242, v241
v_mul_f32 v243, v243, v241
v_cvt_pk_bf16_f32 v4, v242, v243
v_lshlrev_b32 v242, 16, v5
v_and_b32 v243, 0xffff0000, v5
v_sub_f32 v242, v242, v240
v_sub_f32 v243, v243, v240
v_cvt_pk_bf16_f32 v244, v242, v243
v_lshlrev_b32 v242, 16, v244
v_and_b32 v243, 0xffff0000, v244
v_mul_f32 v242, v242, v241
v_mul_f32 v243, v243, v241
v_cvt_pk_bf16_f32 v5, v242, v243
v_lshlrev_b32 v242, 16, v6
v_and_b32 v243, 0xffff0000, v6
v_sub_f32 v242, v242, v240
v_sub_f32 v243, v243, v240
v_cvt_pk_bf16_f32 v244, v242, v243
v_lshlrev_b32 v242, 16, v244
v_and_b32 v243, 0xffff0000, v244
v_mul_f32 v242, v242, v241
v_mul_f32 v243, v243, v241
v_cvt_pk_bf16_f32 v6, v242, v243
v_lshlrev_b32 v242, 16, v7
v_and_b32 v243, 0xffff0000, v7
v_sub_f32 v242, v242, v240
v_sub_f32 v243, v243, v240
v_cvt_pk_bf16_f32 v244, v242, v243
v_lshlrev_b32 v242, 16, v244
v_and_b32 v243, 0xffff0000, v244
v_mul_f32 v242, v242, v241
v_mul_f32 v243, v243, v241
v_cvt_pk_bf16_f32 v7, v242, v243
v_lshlrev_b32 v242, 16, v8
v_and_b32 v243, 0xffff0000, v8
v_sub_f32 v242, v242, v240
v_sub_f32 v243, v243, v240
v_cvt_pk_bf16_f32 v244, v242, v243
v_lshlrev_b32 v242, 16, v244
v_and_b32 v243, 0xffff0000, v244
v_mul_f32 v242, v242, v241
v_mul_f32 v243, v243, v241
v_cvt_pk_bf16_f32 v8, v242, v243
v_lshlrev_b32 v242, 16, v9
v_and_b32 v243, 0xffff0000, v9
v_sub_f32 v242, v242, v240
v_sub_f32 v243, v243, v240
v_cvt_pk_bf16_f32 v244, v242, v243
v_lshlrev_b32 v242, 16, v244
v_and_b32 v243, 0xffff0000, v244
v_mul_f32 v242, v242, v241
v_mul_f32 v243, v243, v241
v_cvt_pk_bf16_f32 v9, v242, v243
v_lshlrev_b32 v242, 16, v10
v_and_b32 v243, 0xffff0000, v10
v_sub_f32 v242, v242, v240
v_sub_f32 v243, v243, v240
v_cvt_pk_bf16_f32 v244, v242, v243
v_lshlrev_b32 v242, 16, v244
v_and_b32 v243, 0xffff0000, v244
v_mul_f32 v242, v242, v241
v_mul_f32 v243, v243, v241
v_cvt_pk_bf16_f32 v10, v242, v243
v_lshlrev_b32 v242, 16, v11
v_and_b32 v243, 0xffff0000, v11
v_sub_f32 v242, v242, v240
v_sub_f32 v243, v243, v240
v_cvt_pk_bf16_f32 v244, v242, v243
v_lshlrev_b32 v242, 16, v244
v_and_b32 v243, 0xffff0000, v244
v_mul_f32 v242, v242, v241
v_mul_f32 v243, v243, v241
v_cvt_pk_bf16_f32 v11, v242, v243
v_lshlrev_b32 v242, 16, v12
v_and_b32 v243, 0xffff0000, v12
v_sub_f32 v242, v242, v240
v_sub_f32 v243, v243, v240
v_cvt_pk_bf16_f32 v244, v242, v243
v_lshlrev_b32 v242, 16, v244
v_and_b32 v243, 0xffff0000, v244
v_mul_f32 v242, v242, v241
v_mul_f32 v243, v243, v241
v_cvt_pk_bf16_f32 v12, v242, v243
v_lshlrev_b32 v242, 16, v13
v_and_b32 v243, 0xffff0000, v13
v_sub_f32 v242, v242, v240
v_sub_f32 v243, v243, v240
v_cvt_pk_bf16_f32 v244, v242, v243
v_lshlrev_b32 v242, 16, v244
v_and_b32 v243, 0xffff0000, v244
v_mul_f32 v242, v242, v241
v_mul_f32 v243, v243, v241
v_cvt_pk_bf16_f32 v13, v242, v243
v_lshlrev_b32 v242, 16, v14
v_and_b32 v243, 0xffff0000, v14
v_sub_f32 v242, v242, v240
v_sub_f32 v243, v243, v240
v_cvt_pk_bf16_f32 v244, v242, v243
v_lshlrev_b32 v242, 16, v244
v_and_b32 v243, 0xffff0000, v244
v_mul_f32 v242, v242, v241
v_mul_f32 v243, v243, v241
v_cvt_pk_bf16_f32 v14, v242, v243
v_lshlrev_b32 v242, 16, v15
v_and_b32 v243, 0xffff0000, v15
v_sub_f32 v242, v242, v240
v_sub_f32 v243, v243, v240
v_cvt_pk_bf16_f32 v244, v242, v243
v_lshlrev_b32 v242, 16, v244
v_and_b32 v243, 0xffff0000, v244
v_mul_f32 v242, v242, v241
v_mul_f32 v243, v243, v241
v_cvt_pk_bf16_f32 v15, v242, v243
ds_write_b128 v237, v[0:3] offset:0
ds_write_b128 v237, v[4:7] offset:1024
ds_write_b128 v237, v[8:11] offset:2048
ds_write_b128 v237, v[12:15] offset:3072
s_lshr_b32 s12, s9, 4
v_add_u32 v246, s12, v248
v_add_u32 v247, s12, v249
buffer_store_dwordx2 v[0:1], v246, s[52:55], 0 offen offset:0
buffer_store_dwordx2 v[2:3], v247, s[52:55], 0 offen offset:0
buffer_store_dwordx2 v[4:5], v246, s[52:55], 0 offen offset:64
buffer_store_dwordx2 v[6:7], v247, s[52:55], 0 offen offset:64
buffer_store_dwordx2 v[8:9], v246, s[52:55], 0 offen offset:128
buffer_store_dwordx2 v[10:11], v247, s[52:55], 0 offen offset:128
buffer_store_dwordx2 v[12:13], v246, s[52:55], 0 offen offset:192
buffer_store_dwordx2 v[14:15], v247, s[52:55], 0 offen offset:192
s_add_u32 s9, s9, 4096
s_cmp_lt_u32 s9, 20480
s_cbranch_scc1 k3_kernel_axn
s_waitcnt lgkmcnt(0)
v_mov_b32 v240, 0
v_mov_b32 v241, 0
s_mov_b32 s9, 0
k3_kernel_bxs:
v_add_u32 v237, s9, v236
ds_read_b128 v[0:3], v237 offset:0
ds_read_b128 v[4:7], v237 offset:1024
ds_read_b128 v[8:11], v237 offset:2048
ds_read_b128 v[12:15], v237 offset:3072
s_waitcnt lgkmcnt(0)
v_lshlrev_b32 v242, 16, v0
v_and_b32 v243, 0xffff0000, v0
v_add_f32 v240, v240, v242
v_add_f32 v240, v240, v243
v_fmac_f32 v241, v242, v242
v_fmac_f32 v241, v243, v243
v_lshlrev_b32 v242, 16, v1
v_and_b32 v243, 0xffff0000, v1
v_add_f32 v240, v240, v242
v_add_f32 v240, v240, v243
v_fmac_f32 v241, v242, v242
v_fmac_f32 v241, v243, v243
v_lshlrev_b32 v242, 16, v2
v_and_b32 v243, 0xffff0000, v2
v_add_f32 v240, v240, v242
v_add_f32 v240, v240, v243
v_fmac_f32 v241, v242, v242
v_fmac_f32 v241, v243, v243
v_lshlrev_b32 v242, 16, v3
v_and_b32 v243, 0xffff0000, v3
v_add_f32 v240, v240, v242
v_add_f32 v240, v240, v243
v_fmac_f32 v241, v242, v242
v_fmac_f32 v241, v243, v243
v_lshlrev_b32 v242, 16, v4
v_and_b32 v243, 0xffff0000, v4
v_add_f32 v240, v240, v242
v_add_f32 v240, v240, v243
v_fmac_f32 v241, v242, v242
v_fmac_f32 v241, v243, v243
v_lshlrev_b32 v242, 16, v5
v_and_b32 v243, 0xffff0000, v5
v_add_f32 v240, v240, v242
v_add_f32 v240, v240, v243
v_fmac_f32 v241, v242, v242
v_fmac_f32 v241, v243, v243
v_lshlrev_b32 v242, 16, v6
v_and_b32 v243, 0xffff0000, v6
v_add_f32 v240, v240, v242
v_add_f32 v240, v240, v243
v_fmac_f32 v241, v242, v242
v_fmac_f32 v241, v243, v243
v_lshlrev_b32 v242, 16, v7
v_and_b32 v243, 0xffff0000, v7
v_add_f32 v240, v240, v242
v_add_f32 v240, v240, v243
v_fmac_f32 v241, v242, v242
v_fmac_f32 v241, v243, v243
v_lshlrev_b32 v242, 16, v8
v_and_b32 v243, 0xffff0000, v8
v_add_f32 v240, v240, v242
v_add_f32 v240, v240, v243
v_fmac_f32 v241, v242, v242
v_fmac_f32 v241, v243, v243
v_lshlrev_b32 v242, 16, v9
v_and_b32 v243, 0xffff0000, v9
v_add_f32 v240, v240, v242
v_add_f32 v240, v240, v243
v_fmac_f32 v241, v242, v242
v_fmac_f32 v241, v243, v243
v_lshlrev_b32 v242, 16, v10
v_and_b32 v243, 0xffff0000, v10
v_add_f32 v240, v240, v242
v_add_f32 v240, v240, v243
v_fmac_f32 v241, v242, v242
v_fmac_f32 v241, v243, v243
v_lshlrev_b32 v242, 16, v11
v_and_b32 v243, 0xffff0000, v11
v_add_f32 v240, v240, v242
v_add_f32 v240, v240, v243
v_fmac_f32 v241, v242, v242
v_fmac_f32 v241, v243, v243
v_lshlrev_b32 v242, 16, v12
v_and_b32 v243, 0xffff0000, v12
v_add_f32 v240, v240, v242
v_add_f32 v240, v240, v243
v_fmac_f32 v241, v242, v242
v_fmac_f32 v241, v243, v243
v_lshlrev_b32 v242, 16, v13
v_and_b32 v243, 0xffff0000, v13
v_add_f32 v240, v240, v242
v_add_f32 v240, v240, v243
v_fmac_f32 v241, v242, v242
v_fmac_f32 v241, v243, v243
v_lshlrev_b32 v242, 16, v14
v_and_b32 v243, 0xffff0000, v14
v_add_f32 v240, v240, v242
v_add_f32 v240, v240, v243
v_fmac_f32 v241, v242, v242
v_fmac_f32 v241, v243, v243
v_lshlrev_b32 v242, 16, v15
v_and_b32 v243, 0xffff0000, v15
v_add_f32 v240, v240, v242
v_add_f32 v240, v240, v243
v_fmac_f32 v241, v242, v242
v_fmac_f32 v241, v243, v243
s_add_u32 s9, s9, 4096
s_cmp_lt_u32 s9, 20480
s_cbranch_scc1 k3_kernel_bxs
ds_bpermute_b32 v244, v250, v240
s_waitcnt lgkmcnt(0)
v_add_f32 v240, v240, v244
ds_bpermute_b32 v244, v251, v240
s_waitcnt lgkmcnt(0)
v_add_f32 v240, v240, v244
ds_bpermute_b32 v244, v250, v241
s_waitcnt lgkmcnt(0)
v_add_f32 v241, v241, v244
ds_bpermute_b32 v244, v251, v241
s_waitcnt lgkmcnt(0)
v_add_f32 v241, v241, v244
v_mul_f32 v240, s42, v240
v_mul_f32 v241, s42, v241
v_fma_f32 v241, -v240, v240, v241
v_max_f32 v241, 0, v241
v_cvt_pk_bf16_f32 v240, v240, v240
v_and_b32 v240, 0xffff0000, v240
v_cvt_pk_bf16_f32 v241, v241, v241
v_and_b32 v241, 0xffff0000, v241
v_add_f32 v241, 0x3727c5ac, v241
v_cvt_pk_bf16_f32 v241, v241, v241
v_and_b32 v241, 0xffff0000, v241
v_sqrt_f32 v241, v241
s_nop 0
v_cvt_pk_bf16_f32 v241, v241, v241
v_and_b32 v241, 0xffff0000, v241
v_rcp_f32 v241, v241
s_mov_b32 s9, 0
k3_kernel_bxn:
v_add_u32 v237, s9, v236
ds_read_b128 v[0:3], v237 offset:0
ds_read_b128 v[4:7], v237 offset:1024
ds_read_b128 v[8:11], v237 offset:2048
ds_read_b128 v[12:15], v237 offset:3072
s_waitcnt lgkmcnt(0)
v_lshlrev_b32 v242, 16, v0
v_and_b32 v243, 0xffff0000, v0
v_sub_f32 v242, v242, v240
v_sub_f32 v243, v243, v240
v_cvt_pk_bf16_f32 v244, v242, v243
v_lshlrev_b32 v242, 16, v244
v_and_b32 v243, 0xffff0000, v244
v_mul_f32 v242, v242, v241
v_mul_f32 v243, v243, v241
v_cvt_pk_bf16_f32 v0, v242, v243
v_lshlrev_b32 v242, 16, v1
v_and_b32 v243, 0xffff0000, v1
v_sub_f32 v242, v242, v240
v_sub_f32 v243, v243, v240
v_cvt_pk_bf16_f32 v244, v242, v243
v_lshlrev_b32 v242, 16, v244
v_and_b32 v243, 0xffff0000, v244
v_mul_f32 v242, v242, v241
v_mul_f32 v243, v243, v241
v_cvt_pk_bf16_f32 v1, v242, v243
v_lshlrev_b32 v242, 16, v2
v_and_b32 v243, 0xffff0000, v2
v_sub_f32 v242, v242, v240
v_sub_f32 v243, v243, v240
v_cvt_pk_bf16_f32 v244, v242, v243
v_lshlrev_b32 v242, 16, v244
v_and_b32 v243, 0xffff0000, v244
v_mul_f32 v242, v242, v241
v_mul_f32 v243, v243, v241
v_cvt_pk_bf16_f32 v2, v242, v243
v_lshlrev_b32 v242, 16, v3
v_and_b32 v243, 0xffff0000, v3
v_sub_f32 v242, v242, v240
v_sub_f32 v243, v243, v240
v_cvt_pk_bf16_f32 v244, v242, v243
v_lshlrev_b32 v242, 16, v244
v_and_b32 v243, 0xffff0000, v244
v_mul_f32 v242, v242, v241
v_mul_f32 v243, v243, v241
v_cvt_pk_bf16_f32 v3, v242, v243
v_lshlrev_b32 v242, 16, v4
v_and_b32 v243, 0xffff0000, v4
v_sub_f32 v242, v242, v240
v_sub_f32 v243, v243, v240
v_cvt_pk_bf16_f32 v244, v242, v243
v_lshlrev_b32 v242, 16, v244
v_and_b32 v243, 0xffff0000, v244
v_mul_f32 v242, v242, v241
v_mul_f32 v243, v243, v241
v_cvt_pk_bf16_f32 v4, v242, v243
v_lshlrev_b32 v242, 16, v5
v_and_b32 v243, 0xffff0000, v5
v_sub_f32 v242, v242, v240
v_sub_f32 v243, v243, v240
v_cvt_pk_bf16_f32 v244, v242, v243
v_lshlrev_b32 v242, 16, v244
v_and_b32 v243, 0xffff0000, v244
v_mul_f32 v242, v242, v241
v_mul_f32 v243, v243, v241
v_cvt_pk_bf16_f32 v5, v242, v243
v_lshlrev_b32 v242, 16, v6
v_and_b32 v243, 0xffff0000, v6
v_sub_f32 v242, v242, v240
v_sub_f32 v243, v243, v240
v_cvt_pk_bf16_f32 v244, v242, v243
v_lshlrev_b32 v242, 16, v244
v_and_b32 v243, 0xffff0000, v244
v_mul_f32 v242, v242, v241
v_mul_f32 v243, v243, v241
v_cvt_pk_bf16_f32 v6, v242, v243
v_lshlrev_b32 v242, 16, v7
v_and_b32 v243, 0xffff0000, v7
v_sub_f32 v242, v242, v240
v_sub_f32 v243, v243, v240
v_cvt_pk_bf16_f32 v244, v242, v243
v_lshlrev_b32 v242, 16, v244
v_and_b32 v243, 0xffff0000, v244
v_mul_f32 v242, v242, v241
v_mul_f32 v243, v243, v241
v_cvt_pk_bf16_f32 v7, v242, v243
v_lshlrev_b32 v242, 16, v8
v_and_b32 v243, 0xffff0000, v8
v_sub_f32 v242, v242, v240
v_sub_f32 v243, v243, v240
v_cvt_pk_bf16_f32 v244, v242, v243
v_lshlrev_b32 v242, 16, v244
v_and_b32 v243, 0xffff0000, v244
v_mul_f32 v242, v242, v241
v_mul_f32 v243, v243, v241
v_cvt_pk_bf16_f32 v8, v242, v243
v_lshlrev_b32 v242, 16, v9
v_and_b32 v243, 0xffff0000, v9
v_sub_f32 v242, v242, v240
v_sub_f32 v243, v243, v240
v_cvt_pk_bf16_f32 v244, v242, v243
v_lshlrev_b32 v242, 16, v244
v_and_b32 v243, 0xffff0000, v244
v_mul_f32 v242, v242, v241
v_mul_f32 v243, v243, v241
v_cvt_pk_bf16_f32 v9, v242, v243
v_lshlrev_b32 v242, 16, v10
v_and_b32 v243, 0xffff0000, v10
v_sub_f32 v242, v242, v240
v_sub_f32 v243, v243, v240
v_cvt_pk_bf16_f32 v244, v242, v243
v_lshlrev_b32 v242, 16, v244
v_and_b32 v243, 0xffff0000, v244
v_mul_f32 v242, v242, v241
v_mul_f32 v243, v243, v241
v_cvt_pk_bf16_f32 v10, v242, v243
v_lshlrev_b32 v242, 16, v11
v_and_b32 v243, 0xffff0000, v11
v_sub_f32 v242, v242, v240
v_sub_f32 v243, v243, v240
v_cvt_pk_bf16_f32 v244, v242, v243
v_lshlrev_b32 v242, 16, v244
v_and_b32 v243, 0xffff0000, v244
v_mul_f32 v242, v242, v241
v_mul_f32 v243, v243, v241
v_cvt_pk_bf16_f32 v11, v242, v243
v_lshlrev_b32 v242, 16, v12
v_and_b32 v243, 0xffff0000, v12
v_sub_f32 v242, v242, v240
v_sub_f32 v243, v243, v240
v_cvt_pk_bf16_f32 v244, v242, v243
v_lshlrev_b32 v242, 16, v244
v_and_b32 v243, 0xffff0000, v244
v_mul_f32 v242, v242, v241
v_mul_f32 v243, v243, v241
v_cvt_pk_bf16_f32 v12, v242, v243
v_lshlrev_b32 v242, 16, v13
v_and_b32 v243, 0xffff0000, v13
v_sub_f32 v242, v242, v240
v_sub_f32 v243, v243, v240
v_cvt_pk_bf16_f32 v244, v242, v243
v_lshlrev_b32 v242, 16, v244
v_and_b32 v243, 0xffff0000, v244
v_mul_f32 v242, v242, v241
v_mul_f32 v243, v243, v241
v_cvt_pk_bf16_f32 v13, v242, v243
v_lshlrev_b32 v242, 16, v14
v_and_b32 v243, 0xffff0000, v14
v_sub_f32 v242, v242, v240
v_sub_f32 v243, v243, v240
v_cvt_pk_bf16_f32 v244, v242, v243
v_lshlrev_b32 v242, 16, v244
v_and_b32 v243, 0xffff0000, v244
v_mul_f32 v242, v242, v241
v_mul_f32 v243, v243, v241
v_cvt_pk_bf16_f32 v14, v242, v243
v_lshlrev_b32 v242, 16, v15
v_and_b32 v243, 0xffff0000, v15
v_sub_f32 v242, v242, v240
v_sub_f32 v243, v243, v240
v_cvt_pk_bf16_f32 v244, v242, v243
v_lshlrev_b32 v242, 16, v244
v_and_b32 v243, 0xffff0000, v244
v_mul_f32 v242, v242, v241
v_mul_f32 v243, v243, v241
v_cvt_pk_bf16_f32 v15, v242, v243
ds_write_b128 v237, v[0:3] offset:0
ds_write_b128 v237, v[4:7] offset:1024
ds_write_b128 v237, v[8:11] offset:2048
ds_write_b128 v237, v[12:15] offset:3072
s_add_u32 s9, s9, 4096
s_cmp_lt_u32 s9, 20480
s_cbranch_scc1 k3_kernel_bxn
s_waitcnt lgkmcnt(0)
v_and_b32 v240, 1, v254
v_lshrrev_b32 v241, 2, v253
v_and_b32 v242, 3, v253
v_lshlrev_b32 v242, 3, v242
v_add_u32 v242, 81920, v242
v_mov_b32 v243, 0
v_lshl_add_u32 v243, v254, 3, v243
v_add_u32 v243, v243, v241
s_movk_i32 s9, 160
v_mad_u32_u24 v244, v243, s9, v242
v_mov_b32 v243, 4
v_lshl_add_u32 v243, v254, 3, v243
v_add_u32 v243, v243, v241
s_movk_i32 s9, 160
v_mad_u32_u24 v245, v243, s9, v242
s_mov_b32 s15, 0
s_mov_b32 s12, 0
k3_kernel_L:
s_waitcnt vmcnt(5)
s_barrier
s_add_u32 s8, s13, s14
s_add_u32 m0, s8, 0
s_nop 0
buffer_load_dwordx4 v192, s[48:51], s10 offen lds
s_add_u32 s8, s13, s14
s_add_u32 m0, s8, 1024
s_nop 0
buffer_load_dwordx4 v193, s[48:51], s10 offen lds
s_add_u32 s8, s13, s14
s_add_u32 m0, s8, 2048
s_nop 0
buffer_load_dwordx4 v194, s[48:51], s10 offen lds
s_add_u32 s8, s13, s14
s_add_u32 m0, s8, 3072
s_nop 0
buffer_load_dwordx4 v195, s[48:51], s10 offen lds
s_add_u32 s8, s13, s14
s_add_u32 m0, s8, 4096
s_nop 0
buffer_load_dwordx4 v196, s[48:51], s10 offen lds
s_add_u32 s10, s10, 163840
s_add_u32 s14, s14, 20480
s_cmp_ge_u32 s14, 61440
s_cselect_b32 s14, 0, s14
v_add_u32 v246, s15, v244
v_add_u32 v247, s15, v245
v_add_u32 v237, s12, v236
ds_read_b128 v[32:35], v237 offset:0
ds_read_b128 v[36:39], v237 offset:1024
ds_read_b128 v[40:43], v237 offset:2048
ds_read_b128 v[44:47], v237 offset:3072
ds_read_b64_tr_b16 v[144:145], v246 offset:0
ds_read_b64_tr_b16 v[146:147], v247 offset:0
ds_read_b64_tr_b16 v[148:149], v246 offset:32
ds_read_b64_tr_b16 v[150:151], v247 offset:32
ds_read_b64_tr_b16 v[152:153], v246 offset:64
ds_read_b64_tr_b16 v[154:155], v247 offset:64
ds_read_b64_tr_b16 v[156:157], v246 offset:96
ds_read_b64_tr_b16 v[158:159], v247 offset:96
ds_read_b64_tr_b16 v[160:161], v246 offset:128
ds_read_b64_tr_b16 v[162:163], v247 offset:128
ds_read_b64_tr_b16 v[164:165], v246 offset:5120
ds_read_b64_tr_b16 v[166:167], v247 offset:5120
s_waitcnt lgkmcnt(10)
v_mfma_f32_16x16x32_bf16 a[0:3], v[144:147], v[32:35], a[0:3]
ds_read_b64_tr_b16 v[168:169], v246 offset:5152
ds_read_b64_tr_b16 v[170:171], v247 offset:5152
s_waitcnt lgkmcnt(10)
v_mfma_f32_16x16x32_bf16 a[4:7], v[148:151], v[32:35], a[4:7]
ds_read_b64_tr_b16 v[144:145], v246 offset:5184
ds_read_b64_tr_b16 v[146:147], v247 offset:5184
s_waitcnt lgkmcnt(10)
v_mfma_f32_16x16x32_bf16 a[8:11], v[152:155], v[32:35], a[8:11]
ds_read_b64_tr_b16 v[148:149], v246 offset:5216
ds_read_b64_tr_b16 v[150:151], v247 offset:5216
s_waitcnt lgkmcnt(10)
v_mfma_f32_16x16x32_bf16 a[12:15], v[156:159], v[32:35], a[12:15]
ds_read_b64_tr_b16 v[152:153], v246 offset:5248
ds_read_b64_tr_b16 v[154:155], v247 offset:5248
s_waitcnt lgkmcnt(10)
v_mfma_f32_16x16x32_bf16 a[16:19], v[160:163], v[32:35], a[16:19]
ds_read_b64_tr_b16 v[156:157], v246 offset:10240
ds_read_b64_tr_b16 v[158:159], v247 offset:10240
s_waitcnt lgkmcnt(10)
v_mfma_f32_16x16x32_bf16 a[0:3], v[164:167], v[36:39], a[0:3]
ds_read_b64_tr_b16 v[160:161], v246 offset:10272
ds_read_b64_tr_b16 v[162:163], v247 offset:10272
s_waitcnt lgkmcnt(10)
v_mfma_f32_16x16x32_bf16 a[4:7], v[168:171], v[36:39], a[4:7]
ds_read_b64_tr_b16 v[164:165], v246 offset:10304
ds_read_b64_tr_b16 v[166:167], v247 offset:10304
s_waitcnt lgkmcnt(10)
v_mfma_f32_16x16x32_bf16 a[8:11], v[144:147], v[36:39], a[8:11]
ds_read_b64_tr_b16 v[168:169], v246 offset:10336
ds_read_b64_tr_b16 v[170:171], v247 offset:10336
s_waitcnt lgkmcnt(10)
v_mfma_f32_16x16x32_bf16 a[12:15], v[148:151], v[36:39], a[12:15]
ds_read_b64_tr_b16 v[144:145], v246 offset:10368
ds_read_b64_tr_b16 v[146:147], v247 offset:10368
s_waitcnt lgkmcnt(10)
v_mfma_f32_16x16x32_bf16 a[16:19], v[152:155], v[36:39], a[16:19]
ds_read_b64_tr_b16 v[148:149], v246 offset:15360
ds_read_b64_tr_b16 v[150:151], v247 offset:15360
s_waitcnt lgkmcnt(10)
v_mfma_f32_16x16x32_bf16 a[0:3], v[156:159], v[40:43], a[0:3]
ds_read_b64_tr_b16 v[152:153], v246 offset:15392
ds_read_b64_tr_b16 v[154:155], v247 offset:15392
s_waitcnt lgkmcnt(10)
v_mfma_f32_16x16x32_bf16 a[4:7], v[160:163], v[40:43], a[4:7]
ds_read_b64_tr_b16 v[156:157], v246 offset:15424
ds_read_b64_tr_b16 v[158:159], v247 offset:15424
s_waitcnt lgkmcnt(10)
v_mfma_f32_16x16x32_bf16 a[8:11], v[164:167], v[40:43], a[8:11]
ds_read_b64_tr_b16 v[160:161], v246 offset:15456
ds_read_b64_tr_b16 v[162:163], v247 offset:15456
s_waitcnt lgkmcnt(10)
v_mfma_f32_16x16x32_bf16 a[12:15], v[168:171], v[40:43], a[12:15]
ds_read_b64_tr_b16 v[164:165], v246 offset:15488
ds_read_b64_tr_b16 v[166:167], v247 offset:15488
s_waitcnt lgkmcnt(10)
v_mfma_f32_16x16x32_bf16 a[16:19], v[144:147], v[40:43], a[16:19]
s_waitcnt lgkmcnt(8)
v_mfma_f32_16x16x32_bf16 a[0:3], v[148:151], v[44:47], a[0:3]
s_waitcnt lgkmcnt(6)
v_mfma_f32_16x16x32_bf16 a[4:7], v[152:155], v[44:47], a[4:7]
s_waitcnt lgkmcnt(4)
v_mfma_f32_16x16x32_bf16 a[8:11], v[156:159], v[44:47], a[8:11]
s_waitcnt lgkmcnt(2)
v_mfma_f32_16x16x32_bf16 a[12:15], v[160:163], v[44:47], a[12:15]
s_waitcnt lgkmcnt(0)
v_mfma_f32_16x16x32_bf16 a[16:19], v[164:167], v[44:47], a[16:19]
s_add_u32 s15, s15, 20480
s_cmp_ge_u32 s15, 61440
s_cselect_b32 s15, 0, s15
s_add_u32 s12, s12, 4096
s_cmp_lt_u32 s12, 20480
s_cbranch_scc1 k3_kernel_L
s_waitcnt vmcnt(0)
s_nop 7
s_nop 7
s_mul_i32 s10, s5, 160
v_lshlrev_b32 v241, 3, v254
v_add_u32 v241, s10, v241
s_movk_i32 s9, 1280
v_mad_u32_u24 v240, v255, s9, v241
s_add_u32 s52, s36, 10485760
s_addc_u32 s53, s37, 0
s_mov_b32 s54, 2621440
s_mov_b32 s55, 0x00020000
v_accvgpr_read_b32 v224, a0
v_cvt_pk_bf16_f32 v224, v224, v224
v_and_b32 v224, 0xffff0000, v224
v_accvgpr_read_b32 v225, a1
v_cvt_pk_bf16_f32 v225, v225, v225
v_and_b32 v225, 0xffff0000, v225
v_accvgpr_read_b32 v226, a2
v_cvt_pk_bf16_f32 v226, v226, v226
v_and_b32 v226, 0xffff0000, v226
v_accvgpr_read_b32 v227, a3
v_cvt_pk_bf16_f32 v227, v227, v227
v_and_b32 v227, 0xffff0000, v227
v_mul_f32 v232, v224, v224
v_fma_f32 v232, v232, s40, 1.0
v_mul_f32 v232, v232, v224
v_mul_f32 v232, s41, v232
v_exp_f32 v232, v232
s_nop 0
v_add_f32 v232, 1.0, v232
v_rcp_f32 v232, v232
s_nop 0
v_mul_f32 v224, v224, v232
v_mul_f32 v232, v225, v225
v_fma_f32 v232, v232, s40, 1.0
v_mul_f32 v232, v232, v225
v_mul_f32 v232, s41, v232
v_exp_f32 v232, v232
s_nop 0
v_add_f32 v232, 1.0, v232
v_rcp_f32 v232, v232
s_nop 0
v_mul_f32 v225, v225, v232
v_mul_f32 v232, v226, v226
v_fma_f32 v232, v232, s40, 1.0
v_mul_f32 v232, v232, v226
v_mul_f32 v232, s41, v232
v_exp_f32 v232, v232
s_nop 0
v_add_f32 v232, 1.0, v232
v_rcp_f32 v232, v232
s_nop 0
v_mul_f32 v226, v226, v232
v_mul_f32 v232, v227, v227
v_fma_f32 v232, v232, s40, 1.0
v_mul_f32 v232, v232, v227
v_mul_f32 v232, s41, v232
v_exp_f32 v232, v232
s_nop 0
v_add_f32 v232, 1.0, v232
v_rcp_f32 v232, v232
s_nop 0
v_mul_f32 v227, v227, v232
v_cvt_pk_bf16_f32 v224, v224, v225
v_cvt_pk_bf16_f32 v225, v226, v227
buffer_store_dwordx2 v[224:225], v240, s[52:55], 0 offen offset:0
s_nop 1
v_accvgpr_read_b32 v224, a4
v_cvt_pk_bf16_f32 v224, v224, v224
v_and_b32 v224, 0xffff0000, v224
v_accvgpr_read_b32 v225, a5
v_cvt_pk_bf16_f32 v225, v225, v225
v_and_b32 v225, 0xffff0000, v225
v_accvgpr_read_b32 v226, a6
v_cvt_pk_bf16_f32 v226, v226, v226
v_and_b32 v226, 0xffff0000, v226
v_accvgpr_read_b32 v227, a7
v_cvt_pk_bf16_f32 v227, v227, v227
v_and_b32 v227, 0xffff0000, v227
v_mul_f32 v232, v224, v224
v_fma_f32 v232, v232, s40, 1.0
v_mul_f32 v232, v232, v224
v_mul_f32 v232, s41, v232
v_exp_f32 v232, v232
s_nop 0
v_add_f32 v232, 1.0, v232
v_rcp_f32 v232, v232
s_nop 0
v_mul_f32 v224, v224, v232
v_mul_f32 v232, v225, v225
v_fma_f32 v232, v232, s40, 1.0
v_mul_f32 v232, v232, v225
v_mul_f32 v232, s41, v232
v_exp_f32 v232, v232
s_nop 0
v_add_f32 v232, 1.0, v232
v_rcp_f32 v232, v232
s_nop 0
v_mul_f32 v225, v225, v232
v_mul_f32 v232, v226, v226
v_fma_f32 v232, v232, s40, 1.0
v_mul_f32 v232, v232, v226
v_mul_f32 v232, s41, v232
v_exp_f32 v232, v232
s_nop 0
v_add_f32 v232, 1.0, v232
v_rcp_f32 v232, v232
s_nop 0
v_mul_f32 v226, v226, v232
v_mul_f32 v232, v227, v227
v_fma_f32 v232, v232, s40, 1.0
v_mul_f32 v232, v232, v227
v_mul_f32 v232, s41, v232
v_exp_f32 v232, v232
s_nop 0
v_add_f32 v232, 1.0, v232
v_rcp_f32 v232, v232
s_nop 0
v_mul_f32 v227, v227, v232
v_cvt_pk_bf16_f32 v224, v224, v225
v_cvt_pk_bf16_f32 v225, v226, v227
buffer_store_dwordx2 v[224:225], v240, s[52:55], 0 offen offset:32
s_nop 1
v_accvgpr_read_b32 v224, a8
v_cvt_pk_bf16_f32 v224, v224, v224
v_and_b32 v224, 0xffff0000, v224
v_accvgpr_read_b32 v225, a9
v_cvt_pk_bf16_f32 v225, v225, v225
v_and_b32 v225, 0xffff0000, v225
v_accvgpr_read_b32 v226, a10
v_cvt_pk_bf16_f32 v226, v226, v226
v_and_b32 v226, 0xffff0000, v226
v_accvgpr_read_b32 v227, a11
v_cvt_pk_bf16_f32 v227, v227, v227
v_and_b32 v227, 0xffff0000, v227
v_mul_f32 v232, v224, v224
v_fma_f32 v232, v232, s40, 1.0
v_mul_f32 v232, v232, v224
v_mul_f32 v232, s41, v232
v_exp_f32 v232, v232
s_nop 0
v_add_f32 v232, 1.0, v232
v_rcp_f32 v232, v232
s_nop 0
v_mul_f32 v224, v224, v232
v_mul_f32 v232, v225, v225
v_fma_f32 v232, v232, s40, 1.0
v_mul_f32 v232, v232, v225
v_mul_f32 v232, s41, v232
v_exp_f32 v232, v232
s_nop 0
v_add_f32 v232, 1.0, v232
v_rcp_f32 v232, v232
s_nop 0
v_mul_f32 v225, v225, v232
v_mul_f32 v232, v226, v226
v_fma_f32 v232, v232, s40, 1.0
v_mul_f32 v232, v232, v226
v_mul_f32 v232, s41, v232
v_exp_f32 v232, v232
s_nop 0
v_add_f32 v232, 1.0, v232
v_rcp_f32 v232, v232
s_nop 0
v_mul_f32 v226, v226, v232
v_mul_f32 v232, v227, v227
v_fma_f32 v232, v232, s40, 1.0
v_mul_f32 v232, v232, v227
v_mul_f32 v232, s41, v232
v_exp_f32 v232, v232
s_nop 0
v_add_f32 v232, 1.0, v232
v_rcp_f32 v232, v232
s_nop 0
v_mul_f32 v227, v227, v232
v_cvt_pk_bf16_f32 v224, v224, v225
v_cvt_pk_bf16_f32 v225, v226, v227
buffer_store_dwordx2 v[224:225], v240, s[52:55], 0 offen offset:64
s_nop 1
v_accvgpr_read_b32 v224, a12
v_cvt_pk_bf16_f32 v224, v224, v224
v_and_b32 v224, 0xffff0000, v224
v_accvgpr_read_b32 v225, a13
v_cvt_pk_bf16_f32 v225, v225, v225
v_and_b32 v225, 0xffff0000, v225
v_accvgpr_read_b32 v226, a14
v_cvt_pk_bf16_f32 v226, v226, v226
v_and_b32 v226, 0xffff0000, v226
v_accvgpr_read_b32 v227, a15
v_cvt_pk_bf16_f32 v227, v227, v227
v_and_b32 v227, 0xffff0000, v227
v_mul_f32 v232, v224, v224
v_fma_f32 v232, v232, s40, 1.0
v_mul_f32 v232, v232, v224
v_mul_f32 v232, s41, v232
v_exp_f32 v232, v232
s_nop 0
v_add_f32 v232, 1.0, v232
v_rcp_f32 v232, v232
s_nop 0
v_mul_f32 v224, v224, v232
v_mul_f32 v232, v225, v225
v_fma_f32 v232, v232, s40, 1.0
v_mul_f32 v232, v232, v225
v_mul_f32 v232, s41, v232
v_exp_f32 v232, v232
s_nop 0
v_add_f32 v232, 1.0, v232
v_rcp_f32 v232, v232
s_nop 0
v_mul_f32 v225, v225, v232
v_mul_f32 v232, v226, v226
v_fma_f32 v232, v232, s40, 1.0
v_mul_f32 v232, v232, v226
v_mul_f32 v232, s41, v232
v_exp_f32 v232, v232
s_nop 0
v_add_f32 v232, 1.0, v232
v_rcp_f32 v232, v232
s_nop 0
v_mul_f32 v226, v226, v232
v_mul_f32 v232, v227, v227
v_fma_f32 v232, v232, s40, 1.0
v_mul_f32 v232, v232, v227
v_mul_f32 v232, s41, v232
v_exp_f32 v232, v232
s_nop 0
v_add_f32 v232, 1.0, v232
v_rcp_f32 v232, v232
s_nop 0
v_mul_f32 v227, v227, v232
v_cvt_pk_bf16_f32 v224, v224, v225
v_cvt_pk_bf16_f32 v225, v226, v227
buffer_store_dwordx2 v[224:225], v240, s[52:55], 0 offen offset:96
s_nop 1
v_accvgpr_read_b32 v224, a16
v_cvt_pk_bf16_f32 v224, v224, v224
v_and_b32 v224, 0xffff0000, v224
v_accvgpr_read_b32 v225, a17
v_cvt_pk_bf16_f32 v225, v225, v225
v_and_b32 v225, 0xffff0000, v225
v_accvgpr_read_b32 v226, a18
v_cvt_pk_bf16_f32 v226, v226, v226
v_and_b32 v226, 0xffff0000, v226
v_accvgpr_read_b32 v227, a19
v_cvt_pk_bf16_f32 v227, v227, v227
v_and_b32 v227, 0xffff0000, v227
v_mul_f32 v232, v224, v224
v_fma_f32 v232, v232, s40, 1.0
v_mul_f32 v232, v232, v224
v_mul_f32 v232, s41, v232
v_exp_f32 v232, v232
s_nop 0
v_add_f32 v232, 1.0, v232
v_rcp_f32 v232, v232
s_nop 0
v_mul_f32 v224, v224, v232
v_mul_f32 v232, v225, v225
v_fma_f32 v232, v232, s40, 1.0
v_mul_f32 v232, v232, v225
v_mul_f32 v232, s41, v232
v_exp_f32 v232, v232
s_nop 0
v_add_f32 v232, 1.0, v232
v_rcp_f32 v232, v232
s_nop 0
v_mul_f32 v225, v225, v232
v_mul_f32 v232, v226, v226
v_fma_f32 v232, v232, s40, 1.0
v_mul_f32 v232, v232, v226
v_mul_f32 v232, s41, v232
v_exp_f32 v232, v232
s_nop 0
v_add_f32 v232, 1.0, v232
v_rcp_f32 v232, v232
s_nop 0
v_mul_f32 v226, v226, v232
v_mul_f32 v232, v227, v227
v_fma_f32 v232, v232, s40, 1.0
v_mul_f32 v232, v232, v227
v_mul_f32 v232, s41, v232
v_exp_f32 v232, v232
s_nop 0
v_add_f32 v232, 1.0, v232
v_rcp_f32 v232, v232
s_nop 0
v_mul_f32 v227, v227, v232
v_cvt_pk_bf16_f32 v224, v224, v225
v_cvt_pk_bf16_f32 v225, v226, v227
buffer_store_dwordx2 v[224:225], v240, s[52:55], 0 offen offset:128
s_nop 1
k3_kernel_end:
s_endpgm
.p2align 8
.globl k4_kernel
.type k4_kernel,@function
k4_kernel:
s_cmp_ge_u32 s2, 256
s_cbranch_scc1 k4_kernel_end
s_load_dwordx16 s[16:31], s[0:1], 0
s_load_dwordx4 s[32:35], s[0:1], 64
s_load_dwordx2 s[36:37], s[0:1], 80
s_mov_b32 s40, 0x3d372713
s_mov_b32 s41, 0xc0135761
s_mov_b32 s42, 0x3acccccd
v_and_b32 v252, 63, v0
v_lshrrev_b32 v253, 6, v0
s_nop 0
v_readfirstlane_b32 s3, v253
v_and_b32 v253, 15, v252
v_lshrrev_b32 v254, 4, v252
v_xor_b32 v250, 16, v252
v_lshlrev_b32 v250, 2, v250
v_xor_b32 v251, 32, v252
v_lshlrev_b32 v251, 2, v251
s_and_b32 s4, s2, 7
s_lshl_b32 s4, s4, 2
s_lshr_b32 s5, s2, 3
s_and_b32 s6, s5, 3
s_add_u32 s4, s4, s6
s_lshr_b32 s5, s5, 2
s_lshl_b32 s6, s4, 6
s_lshl_b32 s7, s3, 4
s_add_u32 s6, s6, s7
v_add_u32 v255, s6, v253
s_waitcnt lgkmcnt(0)
s_add_u32 s44, s36, 10485760
s_addc_u32 s45, s37, 0
s_mov_b32 s46, 2621440
s_mov_b32 s47, 0x00020000
s_mov_b32 s48, s26
s_mov_b32 s49, s27
s_mov_b32 s50, 819200
s_mov_b32 s51, 0x00020000
s_mul_i32 s8, s3, 5120
v_lshlrev_b32 v240, 4, v252
v_add_u32 v240, s8, v240
v_add_u32 v240, 0, v240
v_cvt_f32_u32 v241, v240
s_mov_b32 s9, 0x3bcccccd
v_add_f32 v241, 0.5, v241
v_mul_f32 v241, s9, v241
v_cvt_u32_f32 v241, v241
s_movk_i32 s9, 160
v_mul_lo_u32 v242, v241, s9
v_sub_u32 v242, v240, v242
s_movk_i32 s9, 1280
v_mad_u32_u24 v192, v241, s9, v242
s_mul_i32 s8, s3, 5120
v_lshlrev_b32 v240, 4, v252
v_add_u32 v240, s8, v240
v_add_u32 v240, 1024, v240
v_cvt_f32_u32 v241, v240
s_mov_b32 s9, 0x3bcccccd
v_add_f32 v241, 0.5, v241
v_mul_f32 v241, s9, v241
v_cvt_u32_f32 v241, v241
s_movk_i32 s9, 160
v_mul_lo_u32 v242, v241, s9
v_sub_u32 v242, v240, v242
s_movk_i32 s9, 1280
v_mad_u32_u24 v193, v241, s9, v242
s_mul_i32 s8, s3, 5120
v_lshlrev_b32 v240, 4, v252
v_add_u32 v240, s8, v240
v_add_u32 v240, 2048, v240
v_cvt_f32_u32 v241, v240
s_mov_b32 s9, 0x3bcccccd
v_add_f32 v241, 0.5, v241
v_mul_f32 v241, s9, v241
v_cvt_u32_f32 v241, v241
s_movk_i32 s9, 160
v_mul_lo_u32 v242, v241, s9
v_sub_u32 v242, v240, v242
s_movk_i32 s9, 1280
v_mad_u32_u24 v194, v241, s9, v242
s_mul_i32 s8, s3, 5120
v_lshlrev_b32 v240, 4, v252
v_add_u32 v240, s8, v240
v_add_u32 v240, 3072, v240
v_cvt_f32_u32 v241, v240
s_mov_b32 s9, 0x3bcccccd
v_add_f32 v241, 0.5, v241
v_mul_f32 v241, s9, v241
v_cvt_u32_f32 v241, v241
s_movk_i32 s9, 160
v_mul_lo_u32 v242, v241, s9
v_sub_u32 v242, v240, v242
s_movk_i32 s9, 1280
v_mad_u32_u24 v195, v241, s9, v242
s_mul_i32 s8, s3, 5120
v_lshlrev_b32 v240, 4, v252
v_add_u32 v240, s8, v240
v_add_u32 v240, 4096, v240
v_cvt_f32_u32 v241, v240
s_mov_b32 s9, 0x3bcccccd
v_add_f32 v241, 0.5, v241
v_mul_f32 v241, s9, v241
v_cvt_u32_f32 v241, v241
s_movk_i32 s9, 160
v_mul_lo_u32 v242, v241, s9
v_sub_u32 v242, v240, v242
s_movk_i32 s9, 1280
v_mad_u32_u24 v196, v241, s9, v242
s_mul_i32 s10, s5, 160
s_mul_i32 s13, s3, 5120
s_add_u32 s13, s13, 81920
s_mov_b32 s14, 0
v_and_b32 v240, 1, v254
v_mov_b32 v241, 0
v_lshl_add_u32 v241, v254, 4, v241
s_movk_i32 s9, 1280
v_mad_u32_u24 v248, v255, s9, v241
v_mov_b32 v241, 8
v_lshl_add_u32 v241, v254, 4, v241
s_movk_i32 s9, 1280
v_mad_u32_u24 v249, v255, s9, v241
s_mul_i32 s12, s5, 160
v_lshlrev_b32 v241, 3, v254
v_add_u32 v241, s12, v241
s_movk_i32 s9, 1280
v_mad_u32_u24 v240, v255, s9, v241
s_add_u32 s56, s36, 7864320
s_addc_u32 s57, s37, 0
s_mov_b32 s58, 2621440
s_mov_b32 s59, 0x00020000
buffer_load_dwordx2 a[64:65], v240, s[56:59], 0 offen offset:0
buffer_load_dwordx2 a[66:67], v240, s[56:59], 0 offen offset:32
buffer_load_dwordx2 a[68:69], v240, s[56:59], 0 offen offset:64
buffer_load_dwordx2 a[70:71], v240, s[56:59], 0 offen offset:96
buffer_load_dwordx2 a[72:73], v240, s[56:59], 0 offen offset:128
v_accvgpr_write_b32 a0, 0
v_accvgpr_write_b32 a1, 0
v_accvgpr_write_b32 a2, 0
v_accvgpr_write_b32 a3, 0
v_accvgpr_write_b32 a4, 0
v_accvgpr_write_b32 a5, 0
v_accvgpr_write_b32 a6, 0
v_accvgpr_write_b32 a7, 0
v_accvgpr_write_b32 a8, 0
v_accvgpr_write_b32 a9, 0
v_accvgpr_write_b32 a10, 0
v_accvgpr_write_b32 a11, 0
v_accvgpr_write_b32 a12, 0
v_accvgpr_write_b32 a13, 0
v_accvgpr_write_b32 a14, 0
v_accvgpr_write_b32 a15, 0
v_accvgpr_write_b32 a16, 0
v_accvgpr_write_b32 a17, 0
v_accvgpr_write_b32 a18, 0
v_accvgpr_write_b32 a19, 0
v_lshlrev_b32 v236, 4, v252
s_mul_i32 s8, s3, 20480
v_add_u32 v236, s8, v236
v_subrev_u32 v246, 1280, v248
v_subrev_u32 v247, 1280, v249
s_mul_i32 s8, s3, 20480
s_add_u32 m0, s8, 0
s_movk_i32 s9, 0
buffer_load_dwordx4 v246, s[44:47], s9 offen lds
v_subrev_u32 v246, 1280, v248
v_subrev_u32 v247, 1280, v249
s_mul_i32 s8, s3, 20480
s_add_u32 m0, s8, 1024
s_movk_i32 s9, 64
buffer_load_dwordx4 v246, s[44:47], s9 offen lds
v_subrev_u32 v246, 1280, v248
v_subrev_u32 v247, 1280, v249
s_mul_i32 s8, s3, 20480
s_add_u32 m0, s8, 2048
s_movk_i32 s9, 128
buffer_load_dwordx4 v246, s[44:47], s9 offen lds
v_subrev_u32 v246, 1280, v248
v_subrev_u32 v247, 1280, v249
s_mul_i32 s8, s3, 20480
s_add_u32 m0, s8, 3072
s_movk_i32 s9, 192
buffer_load_dwordx4 v246, s[44:47], s9 offen lds
v_subrev_u32 v246, 1280, v248
v_subrev_u32 v247, 1280, v249
s_mul_i32 s8, s3, 20480
s_add_u32 m0, s8, 4096
s_movk_i32 s9, 256
buffer_load_dwordx4 v246, s[44:47], s9 offen lds
s_mul_i32 s8, s3, 20480
s_add_u32 m0, s8, 5120
s_movk_i32 s9, 1600
buffer_load_dwordx4 v248, s[44:47], s9 offen lds
s_mul_i32 s8, s3, 20480
s_add_u32 m0, s8, 6144
s_movk_i32 s9, 1664
buffer_load_dwordx4 v248, s[44:47], s9 offen lds
s_mul_i32 s8, s3, 20480
s_add_u32 m0, s8, 7168
s_movk_i32 s9, 1728
buffer_load_dwordx4 v248, s[44:47], s9 offen lds
s_mul_i32 s8, s3, 20480
s_add_u32 m0, s8, 8192
s_movk_i32 s9, 1792
buffer_load_dwordx4 v248, s[44:47], s9 offen lds
s_mul_i32 s8, s3, 20480
s_add_u32 m0, s8, 9216
s_movk_i32 s9, 1856
buffer_load_dwordx4 v248, s[44:47], s9 offen lds
v_subrev_u32 v246, 2560, v248
v_subrev_u32 v247, 2560, v249
s_mul_i32 s8, s3, 20480
s_add_u32 m0, s8, 10240
s_movk_i32 s9, 640
buffer_load_dwordx4 v246, s[44:47], s9 offen lds
v_subrev_u32 v246, 2560, v248
v_subrev_u32 v247, 2560, v249
s_mul_i32 s8, s3, 20480
s_add_u32 m0, s8, 11264
s_movk_i32 s9, 704
buffer_load_dwordx4 v246, s[44:47], s9 offen lds
v_subrev_u32 v246, 2560, v248
v_subrev_u32 v247, 2560, v249
s_mul_i32 s8, s3, 20480
s_add_u32 m0, s8, 12288
s_movk_i32 s9, 768
buffer_load_dwordx4 v246, s[44:47], s9 offen lds
v_subrev_u32 v246, 2560, v248
v_subrev_u32 v247, 2560, v249
s_mul_i32 s8, s3, 20480
s_add_u32 m0, s8, 13312
s_movk_i32 s9, 832
buffer_load_dwordx4 v246, s[44:47], s9 offen lds
v_subrev_u32 v246, 2560, v248
v_subrev_u32 v247, 2560, v249
s_mul_i32 s8, s3, 20480
s_add_u32 m0, s8, 14336
s_movk_i32 s9, 896
buffer_load_dwordx4 v246, s[44:47], s9 offen lds
s_mul_i32 s8, s3, 20480
s_add_u32 m0, s8, 15360
s_movk_i32 s9, 3520
buffer_load_dwordx4 v248, s[44:47], s9 offen lds
s_mul_i32 s8, s3, 20480
s_add_u32 m0, s8, 16384
s_movk_i32 s9, 3584
buffer_load_dwordx4 v248, s[44:47], s9 offen lds
s_mul_i32 s8, s3, 20480
s_add_u32 m0, s8, 17408
s_movk_i32 s9, 3648
buffer_load_dwordx4 v248, s[44:47], s9 offen lds
s_mul_i32 s8, s3, 20480
s_add_u32 m0, s8, 18432
s_movk_i32 s9, 3712
buffer_load_dwordx4 v248, s[44:47], s9 offen lds
s_mul_i32 s8, s3, 20480
s_add_u32 m0, s8, 19456
s_movk_i32 s9, 3776
buffer_load_dwordx4 v248, s[44:47], s9 offen lds
s_add_u32 s8, s13, s14
s_add_u32 m0, s8, 0
s_nop 0
buffer_load_dwordx4 v192, s[48:51], s10 offen lds
s_add_u32 s8, s13, s14
s_add_u32 m0, s8, 1024
s_nop 0
buffer_load_dwordx4 v193, s[48:51], s10 offen lds
s_add_u32 s8, s13, s14
s_add_u32 m0, s8, 2048
s_nop 0
buffer_load_dwordx4 v194, s[48:51], s10 offen lds
s_add_u32 s8, s13, s14
s_add_u32 m0, s8, 3072
s_nop 0
buffer_load_dwordx4 v195, s[48:51], s10 offen lds
s_add_u32 s8, s13, s14
s_add_u32 m0, s8, 4096
s_nop 0
buffer_load_dwordx4 v196, s[48:51], s10 offen lds
s_add_u32 s10, s10, 163840
s_add_u32 s14, s14, 20480
s_cmp_ge_u32 s14, 61440
s_cselect_b32 s14, 0, s14
s_add_u32 s8, s13, s14
s_add_u32 m0, s8, 0
s_nop 0
buffer_load_dwordx4 v192, s[48:51], s10 offen lds
s_add_u32 s8, s13, s14
s_add_u32 m0, s8, 1024
s_nop 0
buffer_load_dwordx4 v193, s[48:51], s10 offen lds
s_add_u32 s8, s13, s14
s_add_u32 m0, s8, 2048
s_nop 0
buffer_load_dwordx4 v194, s[48:51], s10 offen lds
s_add_u32 s8, s13, s14
s_add_u32 m0, s8, 3072
s_nop 0
buffer_load_dwordx4 v195, s[48:51], s10 offen lds
s_add_u32 s8, s13, s14
s_add_u32 m0, s8, 4096
s_nop 0
buffer_load_dwordx4 v196, s[48:51], s10 offen lds
s_add_u32 s10, s10, 163840
s_add_u32 s14, s14, 20480
s_cmp_ge_u32 s14, 61440
s_cselect_b32 s14, 0, s14
v_mov_b32 v240, 0
v_mov_b32 v241, 0
s_waitcnt vmcnt(10)
s_waitcnt lgkmcnt(0)
v_and_b32 v240, 1, v254
v_lshrrev_b32 v241, 2, v253
v_and_b32 v242, 3, v253
v_lshlrev_b32 v242, 3, v242
v_add_u32 v242, 81920, v242
v_mov_b32 v243, 0
v_lshl_add_u32 v243, v254, 3, v243
v_add_u32 v243, v243, v241
s_movk_i32 s9, 160
v_mad_u32_u24 v244, v243, s9, v242
v_mov_b32 v243, 4
v_lshl_add_u32 v243, v254, 3, v243
v_add_u32 v243, v243, v241
s_movk_i32 s9, 160
v_mad_u32_u24 v245, v243, s9, v242
s_mov_b32 s15, 0
s_mov_b32 s12, 0
k4_kernel_L:
s_waitcnt vmcnt(5)
s_barrier
s_add_u32 s8, s13, s14
s_add_u32 m0, s8, 0
s_nop 0
buffer_load_dwordx4 v192, s[48:51], s10 offen lds
s_add_u32 s8, s13, s14
s_add_u32 m0, s8, 1024
s_nop 0
buffer_load_dwordx4 v193, s[48:51], s10 offen lds
s_add_u32 s8, s13, s14
s_add_u32 m0, s8, 2048
s_nop 0
buffer_load_dwordx4 v194, s[48:51], s10 offen lds
s_add_u32 s8, s13, s14
s_add_u32 m0, s8, 3072
s_nop 0
buffer_load_dwordx4 v195, s[48:51], s10 offen lds
s_add_u32 s8, s13, s14
s_add_u32 m0, s8, 4096
s_nop 0
buffer_load_dwordx4 v196, s[48:51], s10 offen lds
s_add_u32 s10, s10, 163840
s_add_u32 s14, s14, 20480
s_cmp_ge_u32 s14, 61440
s_cselect_b32 s14, 0, s14
v_add_u32 v246, s15, v244
v_add_u32 v247, s15, v245
v_add_u32 v237, s12, v236
ds_read_b128 v[32:35], v237 offset:0
ds_read_b128 v[36:39], v237 offset:1024
ds_read_b128 v[40:43], v237 offset:2048
ds_read_b128 v[44:47], v237 offset:3072
ds_read_b64_tr_b16 v[144:145], v246 offset:0
ds_read_b64_tr_b16 v[146:147], v247 offset:0
ds_read_b64_tr_b16 v[148:149], v246 offset:32
ds_read_b64_tr_b16 v[150:151], v247 offset:32
ds_read_b64_tr_b16 v[152:153], v246 offset:64
ds_read_b64_tr_b16 v[154:155], v247 offset:64
ds_read_b64_tr_b16 v[156:157], v246 offset:96
ds_read_b64_tr_b16 v[158:159], v247 offset:96
ds_read_b64_tr_b16 v[160:161], v246 offset:128
ds_read_b64_tr_b16 v[162:163], v247 offset:128
ds_read_b64_tr_b16 v[164:165], v246 offset:5120
ds_read_b64_tr_b16 v[166:167], v247 offset:5120
s_waitcnt lgkmcnt(10)
v_mfma_f32_16x16x32_bf16 a[0:3], v[144:147], v[32:35], a[0:3]
ds_read_b64_tr_b16 v[168:169], v246 offset:5152
ds_read_b64_tr_b16 v[170:171], v247 offset:5152
s_waitcnt lgkmcnt(10)
v_mfma_f32_16x16x32_bf16 a[4:7], v[148:151], v[32:35], a[4:7]
ds_read_b64_tr_b16 v[144:145], v246 offset:5184
ds_read_b64_tr_b16 v[146:147], v247 offset:5184
s_waitcnt lgkmcnt(10)
v_mfma_f32_16x16x32_bf16 a[8:11], v[152:155], v[32:35], a[8:11]
ds_read_b64_tr_b16 v[148:149], v246 offset:5216
ds_read_b64_tr_b16 v[150:151], v247 offset:5216
s_waitcnt lgkmcnt(10)
v_mfma_f32_16x16x32_bf16 a[12:15], v[156:159], v[32:35], a[12:15]
ds_read_b64_tr_b16 v[152:153], v246 offset:5248
ds_read_b64_tr_b16 v[154:155], v247 offset:5248
s_waitcnt lgkmcnt(10)
v_mfma_f32_16x16x32_bf16 a[16:19], v[160:163], v[32:35], a[16:19]
ds_read_b64_tr_b16 v[156:157], v246 offset:10240
ds_read_b64_tr_b16 v[158:159], v247 offset:10240
s_waitcnt lgkmcnt(10)
v_mfma_f32_16x16x32_bf16 a[0:3], v[164:167], v[36:39], a[0:3]
ds_read_b64_tr_b16 v[160:161], v246 offset:10272
ds_read_b64_tr_b16 v[162:163], v247 offset:10272
s_waitcnt lgkmcnt(10)
v_mfma_f32_16x16x32_bf16 a[4:7], v[168:171], v[36:39], a[4:7]
ds_read_b64_tr_b16 v[164:165], v246 offset:10304
ds_read_b64_tr_b16 v[166:167], v247 offset:10304
s_waitcnt lgkmcnt(10)
v_mfma_f32_16x16x32_bf16 a[8:11], v[144:147], v[36:39], a[8:11]
ds_read_b64_tr_b16 v[168:169], v246 offset:10336
ds_read_b64_tr_b16 v[170:171], v247 offset:10336
s_waitcnt lgkmcnt(10)
v_mfma_f32_16x16x32_bf16 a[12:15], v[148:151], v[36:39], a[12:15]
ds_read_b64_tr_b16 v[144:145], v246 offset:10368
ds_read_b64_tr_b16 v[146:147], v247 offset:10368
s_waitcnt lgkmcnt(10)
v_mfma_f32_16x16x32_bf16 a[16:19], v[152:155], v[36:39], a[16:19]
ds_read_b64_tr_b16 v[148:149], v246 offset:15360
ds_read_b64_tr_b16 v[150:151], v247 offset:15360
s_waitcnt lgkmcnt(10)
v_mfma_f32_16x16x32_bf16 a[0:3], v[156:159], v[40:43], a[0:3]
ds_read_b64_tr_b16 v[152:153], v246 offset:15392
ds_read_b64_tr_b16 v[154:155], v247 offset:15392
s_waitcnt lgkmcnt(10)
v_mfma_f32_16x16x32_bf16 a[4:7], v[160:163], v[40:43], a[4:7]
ds_read_b64_tr_b16 v[156:157], v246 offset:15424
ds_read_b64_tr_b16 v[158:159], v247 offset:15424
s_waitcnt lgkmcnt(10)
v_mfma_f32_16x16x32_bf16 a[8:11], v[164:167], v[40:43], a[8:11]
ds_read_b64_tr_b16 v[160:161], v246 offset:15456
ds_read_b64_tr_b16 v[162:163], v247 offset:15456
s_waitcnt lgkmcnt(10)
v_mfma_f32_16x16x32_bf16 a[12:15], v[168:171], v[40:43], a[12:15]
ds_read_b64_tr_b16 v[164:165], v246 offset:15488
ds_read_b64_tr_b16 v[166:167], v247 offset:15488
s_waitcnt lgkmcnt(10)
v_mfma_f32_16x16x32_bf16 a[16:19], v[144:147], v[40:43], a[16:19]
s_waitcnt lgkmcnt(8)
v_mfma_f32_16x16x32_bf16 a[0:3], v[148:151], v[44:47], a[0:3]
s_waitcnt lgkmcnt(6)
v_mfma_f32_16x16x32_bf16 a[4:7], v[152:155], v[44:47], a[4:7]
s_waitcnt lgkmcnt(4)
v_mfma_f32_16x16x32_bf16 a[8:11], v[156:159], v[44:47], a[8:11]
s_waitcnt lgkmcnt(2)
v_mfma_f32_16x16x32_bf16 a[12:15], v[160:163], v[44:47], a[12:15]
s_waitcnt lgkmcnt(0)
v_mfma_f32_16x16x32_bf16 a[16:19], v[164:167], v[44:47], a[16:19]
s_add_u32 s15, s15, 20480
s_cmp_ge_u32 s15, 61440
s_cselect_b32 s15, 0, s15
s_add_u32 s12, s12, 4096
s_cmp_lt_u32 s12, 20480
s_cbranch_scc1 k4_kernel_L
s_waitcnt vmcnt(0)
s_nop 7
s_nop 7
s_mul_i32 s10, s5, 160
v_lshlrev_b32 v241, 3, v254
v_add_u32 v241, s10, v241
s_movk_i32 s9, 1280
v_mad_u32_u24 v240, v255, s9, v241
s_add_u32 s52, s36, 13107200
s_addc_u32 s53, s37, 0
s_mov_b32 s54, 2621440
s_mov_b32 s55, 0x00020000
s_add_u32 s56, s36, 7864320
s_addc_u32 s57, s37, 0
s_mov_b32 s58, 2621440
s_mov_b32 s59, 0x00020000
v_accvgpr_read_b32 v228, a64
v_accvgpr_read_b32 v229, a65
v_accvgpr_read_b32 v224, a0
v_cvt_pk_bf16_f32 v224, v224, v224
v_and_b32 v224, 0xffff0000, v224
v_accvgpr_read_b32 v225, a1
v_cvt_pk_bf16_f32 v225, v225, v225
v_and_b32 v225, 0xffff0000, v225
v_accvgpr_read_b32 v226, a2
v_cvt_pk_bf16_f32 v226, v226, v226
v_and_b32 v226, 0xffff0000, v226
v_accvgpr_read_b32 v227, a3
v_cvt_pk_bf16_f32 v227, v227, v227
v_and_b32 v227, 0xffff0000, v227
v_lshlrev_b32 v232, 16, v228
v_and_b32 v233, 0xffff0000, v228
v_add_f32 v224, v224, v232
v_add_f32 v225, v225, v233
v_lshlrev_b32 v232, 16, v229
v_and_b32 v233, 0xffff0000, v229
v_add_f32 v226, v226, v232
v_add_f32 v227, v227, v233
v_cvt_pk_bf16_f32 v224, v224, v225
v_cvt_pk_bf16_f32 v225, v226, v227
buffer_store_dwordx2 v[224:225], v240, s[52:55], 0 offen offset:0
s_nop 1
v_accvgpr_read_b32 v228, a66
v_accvgpr_read_b32 v229, a67
v_accvgpr_read_b32 v224, a4
v_cvt_pk_bf16_f32 v224, v224, v224
v_and_b32 v224, 0xffff0000, v224
v_accvgpr_read_b32 v225, a5
v_cvt_pk_bf16_f32 v225, v225, v225
v_and_b32 v225, 0xffff0000, v225
v_accvgpr_read_b32 v226, a6
v_cvt_pk_bf16_f32 v226, v226, v226
v_and_b32 v226, 0xffff0000, v226
v_accvgpr_read_b32 v227, a7
v_cvt_pk_bf16_f32 v227, v227, v227
v_and_b32 v227, 0xffff0000, v227
v_lshlrev_b32 v232, 16, v228
v_and_b32 v233, 0xffff0000, v228
v_add_f32 v224, v224, v232
v_add_f32 v225, v225, v233
v_lshlrev_b32 v232, 16, v229
v_and_b32 v233, 0xffff0000, v229
v_add_f32 v226, v226, v232
v_add_f32 v227, v227, v233
v_cvt_pk_bf16_f32 v224, v224, v225
v_cvt_pk_bf16_f32 v225, v226, v227
buffer_store_dwordx2 v[224:225], v240, s[52:55], 0 offen offset:32
s_nop 1
v_accvgpr_read_b32 v228, a68
v_accvgpr_read_b32 v229, a69
v_accvgpr_read_b32 v224, a8
v_cvt_pk_bf16_f32 v224, v224, v224
v_and_b32 v224, 0xffff0000, v224
v_accvgpr_read_b32 v225, a9
v_cvt_pk_bf16_f32 v225, v225, v225
v_and_b32 v225, 0xffff0000, v225
v_accvgpr_read_b32 v226, a10
v_cvt_pk_bf16_f32 v226, v226, v226
v_and_b32 v226, 0xffff0000, v226
v_accvgpr_read_b32 v227, a11
v_cvt_pk_bf16_f32 v227, v227, v227
v_and_b32 v227, 0xffff0000, v227
v_lshlrev_b32 v232, 16, v228
v_and_b32 v233, 0xffff0000, v228
v_add_f32 v224, v224, v232
v_add_f32 v225, v225, v233
v_lshlrev_b32 v232, 16, v229
v_and_b32 v233, 0xffff0000, v229
v_add_f32 v226, v226, v232
v_add_f32 v227, v227, v233
v_cvt_pk_bf16_f32 v224, v224, v225
v_cvt_pk_bf16_f32 v225, v226, v227
buffer_store_dwordx2 v[224:225], v240, s[52:55], 0 offen offset:64
s_nop 1
v_accvgpr_read_b32 v228, a70
v_accvgpr_read_b32 v229, a71
v_accvgpr_read_b32 v224, a12
v_cvt_pk_bf16_f32 v224, v224, v224
v_and_b32 v224, 0xffff0000, v224
v_accvgpr_read_b32 v225, a13
v_cvt_pk_bf16_f32 v225, v225, v225
v_and_b32 v225, 0xffff0000, v225
v_accvgpr_read_b32 v226, a14
v_cvt_pk_bf16_f32 v226, v226, v226
v_and_b32 v226, 0xffff0000, v226
v_accvgpr_read_b32 v227, a15
v_cvt_pk_bf16_f32 v227, v227, v227
v_and_b32 v227, 0xffff0000, v227
v_lshlrev_b32 v232, 16, v228
v_and_b32 v233, 0xffff0000, v228
v_add_f32 v224, v224, v232
v_add_f32 v225, v225, v233
v_lshlrev_b32 v232, 16, v229
v_and_b32 v233, 0xffff0000, v229
v_add_f32 v226, v226, v232
v_add_f32 v227, v227, v233
v_cvt_pk_bf16_f32 v224, v224, v225
v_cvt_pk_bf16_f32 v225, v226, v227
buffer_store_dwordx2 v[224:225], v240, s[52:55], 0 offen offset:96
s_nop 1
v_accvgpr_read_b32 v228, a72
v_accvgpr_read_b32 v229, a73
v_accvgpr_read_b32 v224, a16
v_cvt_pk_bf16_f32 v224, v224, v224
v_and_b32 v224, 0xffff0000, v224
v_accvgpr_read_b32 v225, a17
v_cvt_pk_bf16_f32 v225, v225, v225
v_and_b32 v225, 0xffff0000, v225
v_accvgpr_read_b32 v226, a18
v_cvt_pk_bf16_f32 v226, v226, v226
v_and_b32 v226, 0xffff0000, v226
v_accvgpr_read_b32 v227, a19
v_cvt_pk_bf16_f32 v227, v227, v227
v_and_b32 v227, 0xffff0000, v227
v_lshlrev_b32 v232, 16, v228
v_and_b32 v233, 0xffff0000, v228
v_add_f32 v224, v224, v232
v_add_f32 v225, v225, v233
v_lshlrev_b32 v232, 16, v229
v_and_b32 v233, 0xffff0000, v229
v_add_f32 v226, v226, v232
v_add_f32 v227, v227, v233
v_cvt_pk_bf16_f32 v224, v224, v225
v_cvt_pk_bf16_f32 v225, v226, v227
buffer_store_dwordx2 v[224:225], v240, s[52:55], 0 offen offset:128
s_nop 1
k4_kernel_end:
s_endpgm
.p2align 8
.globl k5_kernel
.type k5_kernel,@function
k5_kernel:
s_cmp_ge_u32 s2, 256
s_cbranch_scc1 k5_kernel_end
s_load_dwordx16 s[16:31], s[0:1], 0
s_load_dwordx4 s[32:35], s[0:1], 64
s_load_dwordx2 s[36:37], s[0:1], 80
s_mov_b32 s40, 0x3d372713
s_mov_b32 s41, 0xc0135761
s_mov_b32 s42, 0x3acccccd
v_and_b32 v252, 63, v0
v_lshrrev_b32 v253, 6, v0
s_nop 0
v_readfirstlane_b32 s3, v253
v_and_b32 v253, 15, v252
v_lshrrev_b32 v254, 4, v252
v_xor_b32 v250, 16, v252
v_lshlrev_b32 v250, 2, v250
v_xor_b32 v251, 32, v252
v_lshlrev_b32 v251, 2, v251
s_and_b32 s4, s2, 7
s_lshl_b32 s4, s4, 2
s_lshr_b32 s5, s2, 3
s_and_b32 s6, s5, 3
s_add_u32 s4, s4, s6
s_lshr_b32 s5, s5, 2
s_lshl_b32 s6, s4, 6
s_lshl_b32 s7, s3, 4
s_add_u32 s6, s6, s7
v_add_u32 v255, s6, v253
s_waitcnt lgkmcnt(0)
s_add_u32 s44, s36, 13107200
s_addc_u32 s45, s37, 0
s_mov_b32 s46, 2621440
s_mov_b32 s47, 0x00020000
s_mov_b32 s48, s28
s_mov_b32 s49, s29
s_mov_b32 s50, 1966080
s_mov_b32 s51, 0x00020000
s_mul_i32 s8, s3, 6144
v_lshlrev_b32 v240, 4, v252
v_add_u32 v240, s8, v240
v_add_u32 v240, 0, v240
v_cvt_f32_u32 v241, v240
s_mov_b32 s9, 0x3b2aaaab
v_add_f32 v241, 0.5, v241
v_mul_f32 v241, s9, v241
v_cvt_u32_f32 v241, v241
s_movk_i32 s9, 384
v_mul_lo_u32 v242, v241, s9
v_sub_u32 v242, v240, v242
s_movk_i32 s9, 3072
v_mad_u32_u24 v192, v241, s9, v242
s_mul_i32 s8, s3, 6144
v_lshlrev_b32 v240, 4, v252
v_add_u32 v240, s8, v240
v_add_u32 v240, 1024, v240
v_cvt_f32_u32 v241, v240
s_mov_b32 s9, 0x3b2aaaab
v_add_f32 v241, 0.5, v241
v_mul_f32 v241, s9, v241
v_cvt_u32_f32 v241, v241
s_movk_i32 s9, 384
v_mul_lo_u32 v242, v241, s9
v_sub_u32 v242, v240, v242
s_movk_i32 s9, 3072
v_mad_u32_u24 v193, v241, s9, v242
s_mul_i32 s8, s3, 6144
v_lshlrev_b32 v240, 4, v252
v_add_u32 v240, s8, v240
v_add_u32 v240, 2048, v240
v_cvt_f32_u32 v241, v240
s_mov_b32 s9, 0x3b2aaaab
v_add_f32 v241, 0.5, v241
v_mul_f32 v241, s9, v241
v_cvt_u32_f32 v241, v241
s_movk_i32 s9, 384
v_mul_lo_u32 v242, v241, s9
v_sub_u32 v242, v240, v242
s_movk_i32 s9, 3072
v_mad_u32_u24 v194, v241, s9, v242
s_mul_i32 s8, s3, 6144
v_lshlrev_b32 v240, 4, v252
v_add_u32 v240, s8, v240
v_add_u32 v240, 3072, v240
v_cvt_f32_u32 v241, v240
s_mov_b32 s9, 0x3b2aaaab
v_add_f32 v241, 0.5, v241
v_mul_f32 v241, s9, v241
v_cvt_u32_f32 v241, v241
s_movk_i32 s9, 384
v_mul_lo_u32 v242, v241, s9
v_sub_u32 v242, v240, v242
s_movk_i32 s9, 3072
v_mad_u32_u24 v195, v241, s9, v242
s_mul_i32 s8, s3, 6144
v_lshlrev_b32 v240, 4, v252
v_add_u32 v240, s8, v240
v_add_u32 v240, 4096, v240
v_cvt_f32_u32 v241, v240
s_mov_b32 s9, 0x3b2aaaab
v_add_f32 v241, 0.5, v241
v_mul_f32 v241, s9, v241
v_cvt_u32_f32 v241, v241
s_movk_i32 s9, 384
v_mul_lo_u32 v242, v241, s9
v_sub_u32 v242, v240, v242
s_movk_i32 s9, 3072
v_mad_u32_u24 v196, v241, s9, v242
s_mul_i32 s8, s3, 6144
v_lshlrev_b32 v240, 4, v252
v_add_u32 v240, s8, v240
v_add_u32 v240, 5120, v240
v_cvt_f32_u32 v241, v240
s_mov_b32 s9, 0x3b2aaaab
v_add_f32 v241, 0.5, v241
v_mul_f32 v241, s9, v241
v_cvt_u32_f32 v241, v241
s_movk_i32 s9, 384
v_mul_lo_u32 v242, v241, s9
v_sub_u32 v242, v240, v242
s_movk_i32 s9, 3072
v_mad_u32_u24 v197, v241, s9, v242
s_mul_i32 s10, s5, 384
s_mul_i32 s13, s3, 6144
s_add_u32 s13, s13, 81920
s_mov_b32 s14, 0
v_and_b32 v240, 1, v254
v_mov_b32 v241, 0
v_lshl_add_u32 v241, v254, 4, v241
s_movk_i32 s9, 1280
v_mad_u32_u24 v248, v255, s9, v241
v_mov_b32 v241, 8
v_lshl_add_u32 v241, v254, 4, v241
s_movk_i32 s9, 1280
v_mad_u32_u24 v249, v255, s9, v241
v_accvgpr_write_b32 a0, 0
v_accvgpr_write_b32 a1, 0
v_accvgpr_write_b32 a2, 0
v_accvgpr_write_b32 a3, 0
v_accvgpr_write_b32 a4, 0
v_accvgpr_write_b32 a5, 0
v_accvgpr_write_b32 a6, 0
v_accvgpr_write_b32 a7, 0
v_accvgpr_write_b32 a8, 0
v_accvgpr_write_b32 a9, 0
v_accvgpr_write_b32 a10, 0
v_accvgpr_write_b32 a11, 0
v_accvgpr_write_b32 a12, 0
v_accvgpr_write_b32 a13, 0
v_accvgpr_write_b32 a14, 0
v_accvgpr_write_b32 a15, 0
v_accvgpr_write_b32 a16, 0
v_accvgpr_write_b32 a17, 0
v_accvgpr_write_b32 a18, 0
v_accvgpr_write_b32 a19, 0
v_accvgpr_write_b32 a20, 0
v_accvgpr_write_b32 a21, 0
v_accvgpr_write_b32 a22, 0
v_accvgpr_write_b32 a23, 0
v_accvgpr_write_b32 a24, 0
v_accvgpr_write_b32 a25, 0
v_accvgpr_write_b32 a26, 0
v_accvgpr_write_b32 a27, 0
v_accvgpr_write_b32 a28, 0
v_accvgpr_write_b32 a29, 0
v_accvgpr_write_b32 a30, 0
v_accvgpr_write_b32 a31, 0
v_accvgpr_write_b32 a32, 0
v_accvgpr_write_b32 a33, 0
v_accvgpr_write_b32 a34, 0
v_accvgpr_write_b32 a35, 0
v_accvgpr_write_b32 a36, 0
v_accvgpr_write_b32 a37, 0
v_accvgpr_write_b32 a38, 0
v_accvgpr_write_b32 a39, 0
v_accvgpr_write_b32 a40, 0
v_accvgpr_write_b32 a41, 0
v_accvgpr_write_b32 a42, 0
v_accvgpr_write_b32 a43, 0
v_accvgpr_write_b32 a44, 0
v_accvgpr_write_b32 a45, 0
v_accvgpr_write_b32 a46, 0
v_accvgpr_write_b32 a47, 0
v_lshlrev_b32 v236, 4, v252
s_mul_i32 s8, s3, 20480
v_add_u32 v236, s8, v236
s_mul_i32 s8, s3, 20480
s_add_u32 m0, s8, 0
s_movk_i32 s9, 0
buffer_load_dwordx4 v248, s[44:47], s9 offen lds
s_mul_i32 s8, s3, 20480
s_add_u32 m0, s8, 1024
s_movk_i32 s9, 64
buffer_load_dwordx4 v248, s[44:47], s9 offen lds
s_mul_i32 s8, s3, 20480
s_add_u32 m0, s8, 2048
s_movk_i32 s9, 128
buffer_load_dwordx4 v248, s[44:47], s9 offen lds
s_mul_i32 s8, s3, 20480
s_add_u32 m0, s8, 3072
s_movk_i32 s9, 192
buffer_load_dwordx4 v248, s[44:47], s9 offen lds
s_mul_i32 s8, s3, 20480
s_add_u32 m0, s8, 4096
s_movk_i32 s9, 256
buffer_load_dwordx4 v248, s[44:47], s9 offen lds
s_mul_i32 s8, s3, 20480
s_add_u32 m0, s8, 5120
s_movk_i32 s9, 320
buffer_load_dwordx4 v248, s[44:47], s9 offen lds
s_mul_i32 s8, s3, 20480
s_add_u32 m0, s8, 6144
s_movk_i32 s9, 384
buffer_load_dwordx4 v248, s[44:47], s9 offen lds
s_mul_i32 s8, s3, 20480
s_add_u32 m0, s8, 7168
s_movk_i32 s9, 448
buffer_load_dwordx4 v248, s[44:47], s9 offen lds
s_mul_i32 s8, s3, 20480
s_add_u32 m0, s8, 8192
s_movk_i32 s9, 512
buffer_load_dwordx4 v248, s[44:47], s9 offen lds
s_mul_i32 s8, s3, 20480
s_add_u32 m0, s8, 9216
s_movk_i32 s9, 576
buffer_load_dwordx4 v248, s[44:47], s9 offen lds
s_mul_i32 s8, s3, 20480
s_add_u32 m0, s8, 10240
s_movk_i32 s9, 640
buffer_load_dwordx4 v248, s[44:47], s9 offen lds
s_mul_i32 s8, s3, 20480
s_add_u32 m0, s8, 11264
s_movk_i32 s9, 704
buffer_load_dwordx4 v248, s[44:47], s9 offen lds
s_mul_i32 s8, s3, 20480
s_add_u32 m0, s8, 12288
s_movk_i32 s9, 768
buffer_load_dwordx4 v248, s[44:47], s9 offen lds
s_mul_i32 s8, s3, 20480
s_add_u32 m0, s8, 13312
s_movk_i32 s9, 832
buffer_load_dwordx4 v248, s[44:47], s9 offen lds
s_mul_i32 s8, s3, 20480
s_add_u32 m0, s8, 14336
s_movk_i32 s9, 896
buffer_load_dwordx4 v248, s[44:47], s9 offen lds
s_mul_i32 s8, s3, 20480
s_add_u32 m0, s8, 15360
s_movk_i32 s9, 960
buffer_load_dwordx4 v248, s[44:47], s9 offen lds
s_mul_i32 s8, s3, 20480
s_add_u32 m0, s8, 16384
s_movk_i32 s9, 1024
buffer_load_dwordx4 v248, s[44:47], s9 offen lds
s_mul_i32 s8, s3, 20480
s_add_u32 m0, s8, 17408
s_movk_i32 s9, 1088
buffer_load_dwordx4 v248, s[44:47], s9 offen lds
s_mul_i32 s8, s3, 20480
s_add_u32 m0, s8, 18432
s_movk_i32 s9, 1152
buffer_load_dwordx4 v248, s[44:47], s9 offen lds
s_mul_i32 s8, s3, 20480
s_add_u32 m0, s8, 19456
s_movk_i32 s9, 1216
buffer_load_dwordx4 v248, s[44:47], s9 offen lds
s_add_u32 s8, s13, s14
s_add_u32 m0, s8, 0
s_nop 0
buffer_load_dwordx4 v192, s[48:51], s10 offen lds
s_add_u32 s8, s13, s14
s_add_u32 m0, s8, 1024
s_nop 0
buffer_load_dwordx4 v193, s[48:51], s10 offen lds
s_add_u32 s8, s13, s14
s_add_u32 m0, s8, 2048
s_nop 0
buffer_load_dwordx4 v194, s[48:51], s10 offen lds
s_add_u32 s8, s13, s14
s_add_u32 m0, s8, 3072
s_nop 0
buffer_load_dwordx4 v195, s[48:51], s10 offen lds
s_add_u32 s8, s13, s14
s_add_u32 m0, s8, 4096
s_nop 0
buffer_load_dwordx4 v196, s[48:51], s10 offen lds
s_add_u32 s8, s13, s14
s_add_u32 m0, s8, 5120
s_nop 0
buffer_load_dwordx4 v197, s[48:51], s10 offen lds
s_add_u32 s10, s10, 196608
s_add_u32 s14, s14, 24576
s_cmp_ge_u32 s14, 49152
s_cselect_b32 s14, 0, s14
v_mov_b32 v240, 0
v_mov_b32 v241, 0
s_waitcnt vmcnt(6)
s_waitcnt lgkmcnt(0)
v_mov_b32 v240, 0
v_mov_b32 v241, 0
s_mov_b32 s9, 0
k5_kernel_axs:
v_add_u32 v237, s9, v236
ds_read_b128 v[0:3], v237 offset:0
ds_read_b128 v[4:7], v237 offset:1024
ds_read_b128 v[8:11], v237 offset:2048
ds_read_b128 v[12:15], v237 offset:3072
s_waitcnt lgkmcnt(0)
v_lshlrev_b32 v242, 16, v0
v_and_b32 v243, 0xffff0000, v0
v_add_f32 v240, v240, v242
v_add_f32 v240, v240, v243
v_fmac_f32 v241, v242, v242
v_fmac_f32 v241, v243, v243
v_lshlrev_b32 v242, 16, v1
v_and_b32 v243, 0xffff0000, v1
v_add_f32 v240, v240, v242
v_add_f32 v240, v240, v243
v_fmac_f32 v241, v242, v242
v_fmac_f32 v241, v243, v243
v_lshlrev_b32 v242, 16, v2
v_and_b32 v243, 0xffff0000, v2
v_add_f32 v240, v240, v242
v_add_f32 v240, v240, v243
v_fmac_f32 v241, v242, v242
v_fmac_f32 v241, v243, v243
v_lshlrev_b32 v242, 16, v3
v_and_b32 v243, 0xffff0000, v3
v_add_f32 v240, v240, v242
v_add_f32 v240, v240, v243
v_fmac_f32 v241, v242, v242
v_fmac_f32 v241, v243, v243
v_lshlrev_b32 v242, 16, v4
v_and_b32 v243, 0xffff0000, v4
v_add_f32 v240, v240, v242
v_add_f32 v240, v240, v243
v_fmac_f32 v241, v242, v242
v_fmac_f32 v241, v243, v243
v_lshlrev_b32 v242, 16, v5
v_and_b32 v243, 0xffff0000, v5
v_add_f32 v240, v240, v242
v_add_f32 v240, v240, v243
v_fmac_f32 v241, v242, v242
v_fmac_f32 v241, v243, v243
v_lshlrev_b32 v242, 16, v6
v_and_b32 v243, 0xffff0000, v6
v_add_f32 v240, v240, v242
v_add_f32 v240, v240, v243
v_fmac_f32 v241, v242, v242
v_fmac_f32 v241, v243, v243
v_lshlrev_b32 v242, 16, v7
v_and_b32 v243, 0xffff0000, v7
v_add_f32 v240, v240, v242
v_add_f32 v240, v240, v243
v_fmac_f32 v241, v242, v242
v_fmac_f32 v241, v243, v243
v_lshlrev_b32 v242, 16, v8
v_and_b32 v243, 0xffff0000, v8
v_add_f32 v240, v240, v242
v_add_f32 v240, v240, v243
v_fmac_f32 v241, v242, v242
v_fmac_f32 v241, v243, v243
v_lshlrev_b32 v242, 16, v9
v_and_b32 v243, 0xffff0000, v9
v_add_f32 v240, v240, v242
v_add_f32 v240, v240, v243
v_fmac_f32 v241, v242, v242
v_fmac_f32 v241, v243, v243
v_lshlrev_b32 v242, 16, v10
v_and_b32 v243, 0xffff0000, v10
v_add_f32 v240, v240, v242
v_add_f32 v240, v240, v243
v_fmac_f32 v241, v242, v242
v_fmac_f32 v241, v243, v243
v_lshlrev_b32 v242, 16, v11
v_and_b32 v243, 0xffff0000, v11
v_add_f32 v240, v240, v242
v_add_f32 v240, v240, v243
v_fmac_f32 v241, v242, v242
v_fmac_f32 v241, v243, v243
v_lshlrev_b32 v242, 16, v12
v_and_b32 v243, 0xffff0000, v12
v_add_f32 v240, v240, v242
v_add_f32 v240, v240, v243
v_fmac_f32 v241, v242, v242
v_fmac_f32 v241, v243, v243
v_lshlrev_b32 v242, 16, v13
v_and_b32 v243, 0xffff0000, v13
v_add_f32 v240, v240, v242
v_add_f32 v240, v240, v243
v_fmac_f32 v241, v242, v242
v_fmac_f32 v241, v243, v243
v_lshlrev_b32 v242, 16, v14
v_and_b32 v243, 0xffff0000, v14
v_add_f32 v240, v240, v242
v_add_f32 v240, v240, v243
v_fmac_f32 v241, v242, v242
v_fmac_f32 v241, v243, v243
v_lshlrev_b32 v242, 16, v15
v_and_b32 v243, 0xffff0000, v15
v_add_f32 v240, v240, v242
v_add_f32 v240, v240, v243
v_fmac_f32 v241, v242, v242
v_fmac_f32 v241, v243, v243
s_add_u32 s9, s9, 4096
s_cmp_lt_u32 s9, 20480
s_cbranch_scc1 k5_kernel_axs
ds_bpermute_b32 v244, v250, v240
s_waitcnt lgkmcnt(0)
v_add_f32 v240, v240, v244
ds_bpermute_b32 v244, v251, v240
s_waitcnt lgkmcnt(0)
v_add_f32 v240, v240, v244
ds_bpermute_b32 v244, v250, v241
s_waitcnt lgkmcnt(0)
v_add_f32 v241, v241, v244
ds_bpermute_b32 v244, v251, v241
s_waitcnt lgkmcnt(0)
v_add_f32 v241, v241, v244
v_mul_f32 v240, s42, v240
v_mul_f32 v241, s42, v241
v_fma_f32 v241, -v240, v240, v241
v_max_f32 v241, 0, v241
v_cvt_pk_bf16_f32 v240, v240, v240
v_and_b32 v240, 0xffff0000, v240
v_cvt_pk_bf16_f32 v241, v241, v241
v_and_b32 v241, 0xffff0000, v241
v_add_f32 v241, 0x3727c5ac, v241
v_cvt_pk_bf16_f32 v241, v241, v241
v_and_b32 v241, 0xffff0000, v241
v_sqrt_f32 v241, v241
s_nop 0
v_cvt_pk_bf16_f32 v241, v241, v241
v_and_b32 v241, 0xffff0000, v241
v_rcp_f32 v241, v241
s_mov_b32 s9, 0
k5_kernel_axn:
v_add_u32 v237, s9, v236
ds_read_b128 v[0:3], v237 offset:0
ds_read_b128 v[4:7], v237 offset:1024
ds_read_b128 v[8:11], v237 offset:2048
ds_read_b128 v[12:15], v237 offset:3072
s_waitcnt lgkmcnt(0)
v_lshlrev_b32 v242, 16, v0
v_and_b32 v243, 0xffff0000, v0
v_sub_f32 v242, v242, v240
v_sub_f32 v243, v243, v240
v_cvt_pk_bf16_f32 v244, v242, v243
v_lshlrev_b32 v242, 16, v244
v_and_b32 v243, 0xffff0000, v244
v_mul_f32 v242, v242, v241
v_mul_f32 v243, v243, v241
v_cvt_pk_bf16_f32 v0, v242, v243
v_lshlrev_b32 v242, 16, v1
v_and_b32 v243, 0xffff0000, v1
v_sub_f32 v242, v242, v240
v_sub_f32 v243, v243, v240
v_cvt_pk_bf16_f32 v244, v242, v243
v_lshlrev_b32 v242, 16, v244
v_and_b32 v243, 0xffff0000, v244
v_mul_f32 v242, v242, v241
v_mul_f32 v243, v243, v241
v_cvt_pk_bf16_f32 v1, v242, v243
v_lshlrev_b32 v242, 16, v2
v_and_b32 v243, 0xffff0000, v2
v_sub_f32 v242, v242, v240
v_sub_f32 v243, v243, v240
v_cvt_pk_bf16_f32 v244, v242, v243
v_lshlrev_b32 v242, 16, v244
v_and_b32 v243, 0xffff0000, v244
v_mul_f32 v242, v242, v241
v_mul_f32 v243, v243, v241
v_cvt_pk_bf16_f32 v2, v242, v243
v_lshlrev_b32 v242, 16, v3
v_and_b32 v243, 0xffff0000, v3
v_sub_f32 v242, v242, v240
v_sub_f32 v243, v243, v240
v_cvt_pk_bf16_f32 v244, v242, v243
v_lshlrev_b32 v242, 16, v244
v_and_b32 v243, 0xffff0000, v244
v_mul_f32 v242, v242, v241
v_mul_f32 v243, v243, v241
v_cvt_pk_bf16_f32 v3, v242, v243
v_lshlrev_b32 v242, 16, v4
v_and_b32 v243, 0xffff0000, v4
v_sub_f32 v242, v242, v240
v_sub_f32 v243, v243, v240
v_cvt_pk_bf16_f32 v244, v242, v243
v_lshlrev_b32 v242, 16, v244
v_and_b32 v243, 0xffff0000, v244
v_mul_f32 v242, v242, v241
v_mul_f32 v243, v243, v241
v_cvt_pk_bf16_f32 v4, v242, v243
v_lshlrev_b32 v242, 16, v5
v_and_b32 v243, 0xffff0000, v5
v_sub_f32 v242, v242, v240
v_sub_f32 v243, v243, v240
v_cvt_pk_bf16_f32 v244, v242, v243
v_lshlrev_b32 v242, 16, v244
v_and_b32 v243, 0xffff0000, v244
v_mul_f32 v242, v242, v241
v_mul_f32 v243, v243, v241
v_cvt_pk_bf16_f32 v5, v242, v243
v_lshlrev_b32 v242, 16, v6
v_and_b32 v243, 0xffff0000, v6
v_sub_f32 v242, v242, v240
v_sub_f32 v243, v243, v240
v_cvt_pk_bf16_f32 v244, v242, v243
v_lshlrev_b32 v242, 16, v244
v_and_b32 v243, 0xffff0000, v244
v_mul_f32 v242, v242, v241
v_mul_f32 v243, v243, v241
v_cvt_pk_bf16_f32 v6, v242, v243
v_lshlrev_b32 v242, 16, v7
v_and_b32 v243, 0xffff0000, v7
v_sub_f32 v242, v242, v240
v_sub_f32 v243, v243, v240
v_cvt_pk_bf16_f32 v244, v242, v243
v_lshlrev_b32 v242, 16, v244
v_and_b32 v243, 0xffff0000, v244
v_mul_f32 v242, v242, v241
v_mul_f32 v243, v243, v241
v_cvt_pk_bf16_f32 v7, v242, v243
v_lshlrev_b32 v242, 16, v8
v_and_b32 v243, 0xffff0000, v8
v_sub_f32 v242, v242, v240
v_sub_f32 v243, v243, v240
v_cvt_pk_bf16_f32 v244, v242, v243
v_lshlrev_b32 v242, 16, v244
v_and_b32 v243, 0xffff0000, v244
v_mul_f32 v242, v242, v241
v_mul_f32 v243, v243, v241
v_cvt_pk_bf16_f32 v8, v242, v243
v_lshlrev_b32 v242, 16, v9
v_and_b32 v243, 0xffff0000, v9
v_sub_f32 v242, v242, v240
v_sub_f32 v243, v243, v240
v_cvt_pk_bf16_f32 v244, v242, v243
v_lshlrev_b32 v242, 16, v244
v_and_b32 v243, 0xffff0000, v244
v_mul_f32 v242, v242, v241
v_mul_f32 v243, v243, v241
v_cvt_pk_bf16_f32 v9, v242, v243
v_lshlrev_b32 v242, 16, v10
v_and_b32 v243, 0xffff0000, v10
v_sub_f32 v242, v242, v240
v_sub_f32 v243, v243, v240
v_cvt_pk_bf16_f32 v244, v242, v243
v_lshlrev_b32 v242, 16, v244
v_and_b32 v243, 0xffff0000, v244
v_mul_f32 v242, v242, v241
v_mul_f32 v243, v243, v241
v_cvt_pk_bf16_f32 v10, v242, v243
v_lshlrev_b32 v242, 16, v11
v_and_b32 v243, 0xffff0000, v11
v_sub_f32 v242, v242, v240
v_sub_f32 v243, v243, v240
v_cvt_pk_bf16_f32 v244, v242, v243
v_lshlrev_b32 v242, 16, v244
v_and_b32 v243, 0xffff0000, v244
v_mul_f32 v242, v242, v241
v_mul_f32 v243, v243, v241
v_cvt_pk_bf16_f32 v11, v242, v243
v_lshlrev_b32 v242, 16, v12
v_and_b32 v243, 0xffff0000, v12
v_sub_f32 v242, v242, v240
v_sub_f32 v243, v243, v240
v_cvt_pk_bf16_f32 v244, v242, v243
v_lshlrev_b32 v242, 16, v244
v_and_b32 v243, 0xffff0000, v244
v_mul_f32 v242, v242, v241
v_mul_f32 v243, v243, v241
v_cvt_pk_bf16_f32 v12, v242, v243
v_lshlrev_b32 v242, 16, v13
v_and_b32 v243, 0xffff0000, v13
v_sub_f32 v242, v242, v240
v_sub_f32 v243, v243, v240
v_cvt_pk_bf16_f32 v244, v242, v243
v_lshlrev_b32 v242, 16, v244
v_and_b32 v243, 0xffff0000, v244
v_mul_f32 v242, v242, v241
v_mul_f32 v243, v243, v241
v_cvt_pk_bf16_f32 v13, v242, v243
v_lshlrev_b32 v242, 16, v14
v_and_b32 v243, 0xffff0000, v14
v_sub_f32 v242, v242, v240
v_sub_f32 v243, v243, v240
v_cvt_pk_bf16_f32 v244, v242, v243
v_lshlrev_b32 v242, 16, v244
v_and_b32 v243, 0xffff0000, v244
v_mul_f32 v242, v242, v241
v_mul_f32 v243, v243, v241
v_cvt_pk_bf16_f32 v14, v242, v243
v_lshlrev_b32 v242, 16, v15
v_and_b32 v243, 0xffff0000, v15
v_sub_f32 v242, v242, v240
v_sub_f32 v243, v243, v240
v_cvt_pk_bf16_f32 v244, v242, v243
v_lshlrev_b32 v242, 16, v244
v_and_b32 v243, 0xffff0000, v244
v_mul_f32 v242, v242, v241
v_mul_f32 v243, v243, v241
v_cvt_pk_bf16_f32 v15, v242, v243
ds_write_b128 v237, v[0:3] offset:0
ds_write_b128 v237, v[4:7] offset:1024
ds_write_b128 v237, v[8:11] offset:2048
ds_write_b128 v237, v[12:15] offset:3072
s_add_u32 s9, s9, 4096
s_cmp_lt_u32 s9, 20480
s_cbranch_scc1 k5_kernel_axn
s_waitcnt lgkmcnt(0)
v_and_b32 v240, 1, v254
v_lshrrev_b32 v241, 2, v253
v_and_b32 v242, 3, v253
v_lshlrev_b32 v242, 3, v242
v_add_u32 v242, 81920, v242
v_mov_b32 v243, 0
v_lshl_add_u32 v243, v254, 3, v243
v_add_u32 v243, v243, v241
s_movk_i32 s9, 384
v_mad_u32_u24 v244, v243, s9, v242
v_mov_b32 v243, 4
v_lshl_add_u32 v243, v254, 3, v243
v_add_u32 v243, v243, v241
s_movk_i32 s9, 384
v_mad_u32_u24 v245, v243, s9, v242
s_mov_b32 s15, 0
s_mov_b32 s12, 0
k5_kernel_L:
s_waitcnt vmcnt(0)
s_barrier
s_add_u32 s8, s13, s14
s_add_u32 m0, s8, 0
s_nop 0
buffer_load_dwordx4 v192, s[48:51], s10 offen lds
s_add_u32 s8, s13, s14
s_add_u32 m0, s8, 1024
s_nop 0
buffer_load_dwordx4 v193, s[48:51], s10 offen lds
s_add_u32 s8, s13, s14
s_add_u32 m0, s8, 2048
s_nop 0
buffer_load_dwordx4 v194, s[48:51], s10 offen lds
s_add_u32 s8, s13, s14
s_add_u32 m0, s8, 3072
s_nop 0
buffer_load_dwordx4 v195, s[48:51], s10 offen lds
s_add_u32 s8, s13, s14
s_add_u32 m0, s8, 4096
s_nop 0
buffer_load_dwordx4 v196, s[48:51], s10 offen lds
s_add_u32 s8, s13, s14
s_add_u32 m0, s8, 5120
s_nop 0
buffer_load_dwordx4 v197, s[48:51], s10 offen lds
s_add_u32 s10, s10, 196608
s_add_u32 s14, s14, 24576
s_cmp_ge_u32 s14, 49152
s_cselect_b32 s14, 0, s14
v_add_u32 v246, s15, v244
v_add_u32 v247, s15, v245
v_add_u32 v237, s12, v236
ds_read_b128 v[32:35], v237 offset:0
ds_read_b128 v[36:39], v237 offset:1024
ds_read_b64_tr_b16 v[144:145], v246 offset:0
ds_read_b64_tr_b16 v[146:147], v247 offset:0
ds_read_b64_tr_b16 v[148:149], v246 offset:32
ds_read_b64_tr_b16 v[150:151], v247 offset:32
ds_read_b64_tr_b16 v[152:153], v246 offset:64
ds_read_b64_tr_b16 v[154:155], v247 offset:64
ds_read_b64_tr_b16 v[156:157], v246 offset:96
ds_read_b64_tr_b16 v[158:159], v247 offset:96
ds_read_b64_tr_b16 v[160:161], v246 offset:128
ds_read_b64_tr_b16 v[162:163], v247 offset:128
ds_read_b64_tr_b16 v[164:165], v246 offset:160
ds_read_b64_tr_b16 v[166:167], v247 offset:160
s_waitcnt lgkmcnt(10)
v_mfma_f32_16x16x32_bf16 a[0:3], v[144:147], v[32:35], a[0:3]
ds_read_b64_tr_b16 v[168:169], v246 offset:192
ds_read_b64_tr_b16 v[170:171], v247 offset:192
s_waitcnt lgkmcnt(10)
v_mfma_f32_16x16x32_bf16 a[4:7], v[148:151], v[32:35], a[4:7]
ds_read_b64_tr_b16 v[144:145], v246 offset:224
ds_read_b64_tr_b16 v[146:147], v247 offset:224
s_waitcnt lgkmcnt(10)
v_mfma_f32_16x16x32_bf16 a[8:11], v[152:155], v[32:35], a[8:11]
ds_read_b64_tr_b16 v[148:149], v246 offset:256
ds_read_b64_tr_b16 v[150:151], v247 offset:256
s_waitcnt lgkmcnt(10)
v_mfma_f32_16x16x32_bf16 a[12:15], v[156:159], v[32:35], a[12:15]
ds_read_b64_tr_b16 v[152:153], v246 offset:288
ds_read_b64_tr_b16 v[154:155], v247 offset:288
s_waitcnt lgkmcnt(10)
v_mfma_f32_16x16x32_bf16 a[16:19], v[160:163], v[32:35], a[16:19]
ds_read_b64_tr_b16 v[156:157], v246 offset:320
ds_read_b64_tr_b16 v[158:159], v247 offset:320
s_waitcnt lgkmcnt(10)
v_mfma_f32_16x16x32_bf16 a[20:23], v[164:167], v[32:35], a[20:23]
ds_read_b64_tr_b16 v[160:161], v246 offset:352
ds_read_b64_tr_b16 v[162:163], v247 offset:352
s_waitcnt lgkmcnt(10)
v_mfma_f32_16x16x32_bf16 a[24:27], v[168:171], v[32:35], a[24:27]
ds_read_b64_tr_b16 v[164:165], v246 offset:12288
ds_read_b64_tr_b16 v[166:167], v247 offset:12288
s_waitcnt lgkmcnt(10)
v_mfma_f32_16x16x32_bf16 a[28:31], v[144:147], v[32:35], a[28:31]
ds_read_b64_tr_b16 v[168:169], v246 offset:12320
ds_read_b64_tr_b16 v[170:171], v247 offset:12320
s_waitcnt lgkmcnt(10)
v_mfma_f32_16x16x32_bf16 a[32:35], v[148:151], v[32:35], a[32:35]
ds_read_b64_tr_b16 v[144:145], v246 offset:12352
ds_read_b64_tr_b16 v[146:147], v247 offset:12352
s_waitcnt lgkmcnt(10)
v_mfma_f32_16x16x32_bf16 a[36:39], v[152:155], v[32:35], a[36:39]
ds_read_b64_tr_b16 v[148:149], v246 offset:12384
ds_read_b64_tr_b16 v[150:151], v247 offset:12384
s_waitcnt lgkmcnt(10)
v_mfma_f32_16x16x32_bf16 a[40:43], v[156:159], v[32:35], a[40:43]
ds_read_b64_tr_b16 v[152:153], v246 offset:12416
ds_read_b64_tr_b16 v[154:155], v247 offset:12416
s_waitcnt lgkmcnt(10)
v_mfma_f32_16x16x32_bf16 a[44:47], v[160:163], v[32:35], a[44:47]
ds_read_b64_tr_b16 v[156:157], v246 offset:12448
ds_read_b64_tr_b16 v[158:159], v247 offset:12448
s_waitcnt lgkmcnt(10)
v_mfma_f32_16x16x32_bf16 a[0:3], v[164:167], v[36:39], a[0:3]
ds_read_b64_tr_b16 v[160:161], v246 offset:12480
ds_read_b64_tr_b16 v[162:163], v247 offset:12480
s_waitcnt lgkmcnt(10)
v_mfma_f32_16x16x32_bf16 a[4:7], v[168:171], v[36:39], a[4:7]
ds_read_b64_tr_b16 v[164:165], v246 offset:12512
ds_read_b64_tr_b16 v[166:167], v247 offset:12512
s_waitcnt lgkmcnt(10)
v_mfma_f32_16x16x32_bf16 a[8:11], v[144:147], v[36:39], a[8:11]
ds_read_b64_tr_b16 v[168:169], v246 offset:12544
ds_read_b64_tr_b16 v[170:171], v247 offset:12544
s_waitcnt lgkmcnt(10)
v_mfma_f32_16x16x32_bf16 a[12:15], v[148:151], v[36:39], a[12:15]
ds_read_b64_tr_b16 v[144:145], v246 offset:12576
ds_read_b64_tr_b16 v[146:147], v247 offset:12576
s_waitcnt lgkmcnt(10)
v_mfma_f32_16x16x32_bf16 a[16:19], v[152:155], v[36:39], a[16:19]
ds_read_b64_tr_b16 v[148:149], v246 offset:12608
ds_read_b64_tr_b16 v[150:151], v247 offset:12608
s_waitcnt lgkmcnt(10)
v_mfma_f32_16x16x32_bf16 a[20:23], v[156:159], v[36:39], a[20:23]
ds_read_b64_tr_b16 v[152:153], v246 offset:12640
ds_read_b64_tr_b16 v[154:155], v247 offset:12640
s_waitcnt lgkmcnt(10)
v_mfma_f32_16x16x32_bf16 a[24:27], v[160:163], v[36:39], a[24:27]
s_waitcnt lgkmcnt(8)
v_mfma_f32_16x16x32_bf16 a[28:31], v[164:167], v[36:39], a[28:31]
s_waitcnt lgkmcnt(6)
v_mfma_f32_16x16x32_bf16 a[32:35], v[168:171], v[36:39], a[32:35]
s_waitcnt lgkmcnt(4)
v_mfma_f32_16x16x32_bf16 a[36:39], v[144:147], v[36:39], a[36:39]
s_waitcnt lgkmcnt(2)
v_mfma_f32_16x16x32_bf16 a[40:43], v[148:151], v[36:39], a[40:43]
s_waitcnt lgkmcnt(0)
v_mfma_f32_16x16x32_bf16 a[44:47], v[152:155], v[36:39], a[44:47]
s_add_u32 s15, s15, 24576
s_cmp_ge_u32 s15, 49152
s_cselect_b32 s15, 0, s15
s_add_u32 s12, s12, 2048
s_cmp_lt_u32 s12, 20480
s_cbranch_scc1 k5_kernel_L
s_waitcnt vmcnt(0)
s_nop 7
s_nop 7
s_mul_i32 s10, s5, 384
v_lshlrev_b32 v241, 3, v254
v_add_u32 v241, s10, v241
s_movk_i32 s9, 3072
v_mad_u32_u24 v240, v255, s9, v241
s_add_u32 s52, s36, 15728640
s_addc_u32 s53, s37, 0
s_mov_b32 s54, 6291456
s_mov_b32 s55, 0x00020000
v_accvgpr_read_b32 v224, a0
v_cvt_pk_bf16_f32 v224, v224, v224
v_and_b32 v224, 0xffff0000, v224
v_accvgpr_read_b32 v225, a1
v_cvt_pk_bf16_f32 v225, v225, v225
v_and_b32 v225, 0xffff0000, v225
v_accvgpr_read_b32 v226, a2
v_cvt_pk_bf16_f32 v226, v226, v226
v_and_b32 v226, 0xffff0000, v226
v_accvgpr_read_b32 v227, a3
v_cvt_pk_bf16_f32 v227, v227, v227
v_and_b32 v227, 0xffff0000, v227
v_mul_f32 v232, v224, v224
v_fma_f32 v232, v232, s40, 1.0
v_mul_f32 v232, v232, v224
v_mul_f32 v232, s41, v232
v_exp_f32 v232, v232
s_nop 0
v_add_f32 v232, 1.0, v232
v_rcp_f32 v232, v232
s_nop 0
v_mul_f32 v224, v224, v232
v_mul_f32 v232, v225, v225
v_fma_f32 v232, v232, s40, 1.0
v_mul_f32 v232, v232, v225
v_mul_f32 v232, s41, v232
v_exp_f32 v232, v232
s_nop 0
v_add_f32 v232, 1.0, v232
v_rcp_f32 v232, v232
s_nop 0
v_mul_f32 v225, v225, v232
v_mul_f32 v232, v226, v226
v_fma_f32 v232, v232, s40, 1.0
v_mul_f32 v232, v232, v226
v_mul_f32 v232, s41, v232
v_exp_f32 v232, v232
s_nop 0
v_add_f32 v232, 1.0, v232
v_rcp_f32 v232, v232
s_nop 0
v_mul_f32 v226, v226, v232
v_mul_f32 v232, v227, v227
v_fma_f32 v232, v232, s40, 1.0
v_mul_f32 v232, v232, v227
v_mul_f32 v232, s41, v232
v_exp_f32 v232, v232
s_nop 0
v_add_f32 v232, 1.0, v232
v_rcp_f32 v232, v232
s_nop 0
v_mul_f32 v227, v227, v232
v_cvt_pk_bf16_f32 v224, v224, v225
v_cvt_pk_bf16_f32 v225, v226, v227
buffer_store_dwordx2 v[224:225], v240, s[52:55], 0 offen offset:0
s_nop 1
v_accvgpr_read_b32 v224, a4
v_cvt_pk_bf16_f32 v224, v224, v224
v_and_b32 v224, 0xffff0000, v224
v_accvgpr_read_b32 v225, a5
v_cvt_pk_bf16_f32 v225, v225, v225
v_and_b32 v225, 0xffff0000, v225
v_accvgpr_read_b32 v226, a6
v_cvt_pk_bf16_f32 v226, v226, v226
v_and_b32 v226, 0xffff0000, v226
v_accvgpr_read_b32 v227, a7
v_cvt_pk_bf16_f32 v227, v227, v227
v_and_b32 v227, 0xffff0000, v227
v_mul_f32 v232, v224, v224
v_fma_f32 v232, v232, s40, 1.0
v_mul_f32 v232, v232, v224
v_mul_f32 v232, s41, v232
v_exp_f32 v232, v232
s_nop 0
v_add_f32 v232, 1.0, v232
v_rcp_f32 v232, v232
s_nop 0
v_mul_f32 v224, v224, v232
v_mul_f32 v232, v225, v225
v_fma_f32 v232, v232, s40, 1.0
v_mul_f32 v232, v232, v225
v_mul_f32 v232, s41, v232
v_exp_f32 v232, v232
s_nop 0
v_add_f32 v232, 1.0, v232
v_rcp_f32 v232, v232
s_nop 0
v_mul_f32 v225, v225, v232
v_mul_f32 v232, v226, v226
v_fma_f32 v232, v232, s40, 1.0
v_mul_f32 v232, v232, v226
v_mul_f32 v232, s41, v232
v_exp_f32 v232, v232
s_nop 0
v_add_f32 v232, 1.0, v232
v_rcp_f32 v232, v232
s_nop 0
v_mul_f32 v226, v226, v232
v_mul_f32 v232, v227, v227
v_fma_f32 v232, v232, s40, 1.0
v_mul_f32 v232, v232, v227
v_mul_f32 v232, s41, v232
v_exp_f32 v232, v232
s_nop 0
v_add_f32 v232, 1.0, v232
v_rcp_f32 v232, v232
s_nop 0
v_mul_f32 v227, v227, v232
v_cvt_pk_bf16_f32 v224, v224, v225
v_cvt_pk_bf16_f32 v225, v226, v227
buffer_store_dwordx2 v[224:225], v240, s[52:55], 0 offen offset:32
s_nop 1
v_accvgpr_read_b32 v224, a8
v_cvt_pk_bf16_f32 v224, v224, v224
v_and_b32 v224, 0xffff0000, v224
v_accvgpr_read_b32 v225, a9
v_cvt_pk_bf16_f32 v225, v225, v225
v_and_b32 v225, 0xffff0000, v225
v_accvgpr_read_b32 v226, a10
v_cvt_pk_bf16_f32 v226, v226, v226
v_and_b32 v226, 0xffff0000, v226
v_accvgpr_read_b32 v227, a11
v_cvt_pk_bf16_f32 v227, v227, v227
v_and_b32 v227, 0xffff0000, v227
v_mul_f32 v232, v224, v224
v_fma_f32 v232, v232, s40, 1.0
v_mul_f32 v232, v232, v224
v_mul_f32 v232, s41, v232
v_exp_f32 v232, v232
s_nop 0
v_add_f32 v232, 1.0, v232
v_rcp_f32 v232, v232
s_nop 0
v_mul_f32 v224, v224, v232
v_mul_f32 v232, v225, v225
v_fma_f32 v232, v232, s40, 1.0
v_mul_f32 v232, v232, v225
v_mul_f32 v232, s41, v232
v_exp_f32 v232, v232
s_nop 0
v_add_f32 v232, 1.0, v232
v_rcp_f32 v232, v232
s_nop 0
v_mul_f32 v225, v225, v232
v_mul_f32 v232, v226, v226
v_fma_f32 v232, v232, s40, 1.0
v_mul_f32 v232, v232, v226
v_mul_f32 v232, s41, v232
v_exp_f32 v232, v232
s_nop 0
v_add_f32 v232, 1.0, v232
v_rcp_f32 v232, v232
s_nop 0
v_mul_f32 v226, v226, v232
v_mul_f32 v232, v227, v227
v_fma_f32 v232, v232, s40, 1.0
v_mul_f32 v232, v232, v227
v_mul_f32 v232, s41, v232
v_exp_f32 v232, v232
s_nop 0
v_add_f32 v232, 1.0, v232
v_rcp_f32 v232, v232
s_nop 0
v_mul_f32 v227, v227, v232
v_cvt_pk_bf16_f32 v224, v224, v225
v_cvt_pk_bf16_f32 v225, v226, v227
buffer_store_dwordx2 v[224:225], v240, s[52:55], 0 offen offset:64
s_nop 1
v_accvgpr_read_b32 v224, a12
v_cvt_pk_bf16_f32 v224, v224, v224
v_and_b32 v224, 0xffff0000, v224
v_accvgpr_read_b32 v225, a13
v_cvt_pk_bf16_f32 v225, v225, v225
v_and_b32 v225, 0xffff0000, v225
v_accvgpr_read_b32 v226, a14
v_cvt_pk_bf16_f32 v226, v226, v226
v_and_b32 v226, 0xffff0000, v226
v_accvgpr_read_b32 v227, a15
v_cvt_pk_bf16_f32 v227, v227, v227
v_and_b32 v227, 0xffff0000, v227
v_mul_f32 v232, v224, v224
v_fma_f32 v232, v232, s40, 1.0
v_mul_f32 v232, v232, v224
v_mul_f32 v232, s41, v232
v_exp_f32 v232, v232
s_nop 0
v_add_f32 v232, 1.0, v232
v_rcp_f32 v232, v232
s_nop 0
v_mul_f32 v224, v224, v232
v_mul_f32 v232, v225, v225
v_fma_f32 v232, v232, s40, 1.0
v_mul_f32 v232, v232, v225
v_mul_f32 v232, s41, v232
v_exp_f32 v232, v232
s_nop 0
v_add_f32 v232, 1.0, v232
v_rcp_f32 v232, v232
s_nop 0
v_mul_f32 v225, v225, v232
v_mul_f32 v232, v226, v226
v_fma_f32 v232, v232, s40, 1.0
v_mul_f32 v232, v232, v226
v_mul_f32 v232, s41, v232
v_exp_f32 v232, v232
s_nop 0
v_add_f32 v232, 1.0, v232
v_rcp_f32 v232, v232
s_nop 0
v_mul_f32 v226, v226, v232
v_mul_f32 v232, v227, v227
v_fma_f32 v232, v232, s40, 1.0
v_mul_f32 v232, v232, v227
v_mul_f32 v232, s41, v232
v_exp_f32 v232, v232
s_nop 0
v_add_f32 v232, 1.0, v232
v_rcp_f32 v232, v232
s_nop 0
v_mul_f32 v227, v227, v232
v_cvt_pk_bf16_f32 v224, v224, v225
v_cvt_pk_bf16_f32 v225, v226, v227
buffer_store_dwordx2 v[224:225], v240, s[52:55], 0 offen offset:96
s_nop 1
v_accvgpr_read_b32 v224, a16
v_cvt_pk_bf16_f32 v224, v224, v224
v_and_b32 v224, 0xffff0000, v224
v_accvgpr_read_b32 v225, a17
v_cvt_pk_bf16_f32 v225, v225, v225
v_and_b32 v225, 0xffff0000, v225
v_accvgpr_read_b32 v226, a18
v_cvt_pk_bf16_f32 v226, v226, v226
v_and_b32 v226, 0xffff0000, v226
v_accvgpr_read_b32 v227, a19
v_cvt_pk_bf16_f32 v227, v227, v227
v_and_b32 v227, 0xffff0000, v227
v_mul_f32 v232, v224, v224
v_fma_f32 v232, v232, s40, 1.0
v_mul_f32 v232, v232, v224
v_mul_f32 v232, s41, v232
v_exp_f32 v232, v232
s_nop 0
v_add_f32 v232, 1.0, v232
v_rcp_f32 v232, v232
s_nop 0
v_mul_f32 v224, v224, v232
v_mul_f32 v232, v225, v225
v_fma_f32 v232, v232, s40, 1.0
v_mul_f32 v232, v232, v225
v_mul_f32 v232, s41, v232
v_exp_f32 v232, v232
s_nop 0
v_add_f32 v232, 1.0, v232
v_rcp_f32 v232, v232
s_nop 0
v_mul_f32 v225, v225, v232
v_mul_f32 v232, v226, v226
v_fma_f32 v232, v232, s40, 1.0
v_mul_f32 v232, v232, v226
v_mul_f32 v232, s41, v232
v_exp_f32 v232, v232
s_nop 0
v_add_f32 v232, 1.0, v232
v_rcp_f32 v232, v232
s_nop 0
v_mul_f32 v226, v226, v232
v_mul_f32 v232, v227, v227
v_fma_f32 v232, v232, s40, 1.0
v_mul_f32 v232, v232, v227
v_mul_f32 v232, s41, v232
v_exp_f32 v232, v232
s_nop 0
v_add_f32 v232, 1.0, v232
v_rcp_f32 v232, v232
s_nop 0
v_mul_f32 v227, v227, v232
v_cvt_pk_bf16_f32 v224, v224, v225
v_cvt_pk_bf16_f32 v225, v226, v227
buffer_store_dwordx2 v[224:225], v240, s[52:55], 0 offen offset:128
s_nop 1
v_accvgpr_read_b32 v224, a20
v_cvt_pk_bf16_f32 v224, v224, v224
v_and_b32 v224, 0xffff0000, v224
v_accvgpr_read_b32 v225, a21
v_cvt_pk_bf16_f32 v225, v225, v225
v_and_b32 v225, 0xffff0000, v225
v_accvgpr_read_b32 v226, a22
v_cvt_pk_bf16_f32 v226, v226, v226
v_and_b32 v226, 0xffff0000, v226
v_accvgpr_read_b32 v227, a23
v_cvt_pk_bf16_f32 v227, v227, v227
v_and_b32 v227, 0xffff0000, v227
v_mul_f32 v232, v224, v224
v_fma_f32 v232, v232, s40, 1.0
v_mul_f32 v232, v232, v224
v_mul_f32 v232, s41, v232
v_exp_f32 v232, v232
s_nop 0
v_add_f32 v232, 1.0, v232
v_rcp_f32 v232, v232
s_nop 0
v_mul_f32 v224, v224, v232
v_mul_f32 v232, v225, v225
v_fma_f32 v232, v232, s40, 1.0
v_mul_f32 v232, v232, v225
v_mul_f32 v232, s41, v232
v_exp_f32 v232, v232
s_nop 0
v_add_f32 v232, 1.0, v232
v_rcp_f32 v232, v232
s_nop 0
v_mul_f32 v225, v225, v232
v_mul_f32 v232, v226, v226
v_fma_f32 v232, v232, s40, 1.0
v_mul_f32 v232, v232, v226
v_mul_f32 v232, s41, v232
v_exp_f32 v232, v232
s_nop 0
v_add_f32 v232, 1.0, v232
v_rcp_f32 v232, v232
s_nop 0
v_mul_f32 v226, v226, v232
v_mul_f32 v232, v227, v227
v_fma_f32 v232, v232, s40, 1.0
v_mul_f32 v232, v232, v227
v_mul_f32 v232, s41, v232
v_exp_f32 v232, v232
s_nop 0
v_add_f32 v232, 1.0, v232
v_rcp_f32 v232, v232
s_nop 0
v_mul_f32 v227, v227, v232
v_cvt_pk_bf16_f32 v224, v224, v225
v_cvt_pk_bf16_f32 v225, v226, v227
buffer_store_dwordx2 v[224:225], v240, s[52:55], 0 offen offset:160
s_nop 1
v_accvgpr_read_b32 v224, a24
v_cvt_pk_bf16_f32 v224, v224, v224
v_and_b32 v224, 0xffff0000, v224
v_accvgpr_read_b32 v225, a25
v_cvt_pk_bf16_f32 v225, v225, v225
v_and_b32 v225, 0xffff0000, v225
v_accvgpr_read_b32 v226, a26
v_cvt_pk_bf16_f32 v226, v226, v226
v_and_b32 v226, 0xffff0000, v226
v_accvgpr_read_b32 v227, a27
v_cvt_pk_bf16_f32 v227, v227, v227
v_and_b32 v227, 0xffff0000, v227
v_mul_f32 v232, v224, v224
v_fma_f32 v232, v232, s40, 1.0
v_mul_f32 v232, v232, v224
v_mul_f32 v232, s41, v232
v_exp_f32 v232, v232
s_nop 0
v_add_f32 v232, 1.0, v232
v_rcp_f32 v232, v232
s_nop 0
v_mul_f32 v224, v224, v232
v_mul_f32 v232, v225, v225
v_fma_f32 v232, v232, s40, 1.0
v_mul_f32 v232, v232, v225
v_mul_f32 v232, s41, v232
v_exp_f32 v232, v232
s_nop 0
v_add_f32 v232, 1.0, v232
v_rcp_f32 v232, v232
s_nop 0
v_mul_f32 v225, v225, v232
v_mul_f32 v232, v226, v226
v_fma_f32 v232, v232, s40, 1.0
v_mul_f32 v232, v232, v226
v_mul_f32 v232, s41, v232
v_exp_f32 v232, v232
s_nop 0
v_add_f32 v232, 1.0, v232
v_rcp_f32 v232, v232
s_nop 0
v_mul_f32 v226, v226, v232
v_mul_f32 v232, v227, v227
v_fma_f32 v232, v232, s40, 1.0
v_mul_f32 v232, v232, v227
v_mul_f32 v232, s41, v232
v_exp_f32 v232, v232
s_nop 0
v_add_f32 v232, 1.0, v232
v_rcp_f32 v232, v232
s_nop 0
v_mul_f32 v227, v227, v232
v_cvt_pk_bf16_f32 v224, v224, v225
v_cvt_pk_bf16_f32 v225, v226, v227
buffer_store_dwordx2 v[224:225], v240, s[52:55], 0 offen offset:192
s_nop 1
v_accvgpr_read_b32 v224, a28
v_cvt_pk_bf16_f32 v224, v224, v224
v_and_b32 v224, 0xffff0000, v224
v_accvgpr_read_b32 v225, a29
v_cvt_pk_bf16_f32 v225, v225, v225
v_and_b32 v225, 0xffff0000, v225
v_accvgpr_read_b32 v226, a30
v_cvt_pk_bf16_f32 v226, v226, v226
v_and_b32 v226, 0xffff0000, v226
v_accvgpr_read_b32 v227, a31
v_cvt_pk_bf16_f32 v227, v227, v227
v_and_b32 v227, 0xffff0000, v227
v_mul_f32 v232, v224, v224
v_fma_f32 v232, v232, s40, 1.0
v_mul_f32 v232, v232, v224
v_mul_f32 v232, s41, v232
v_exp_f32 v232, v232
s_nop 0
v_add_f32 v232, 1.0, v232
v_rcp_f32 v232, v232
s_nop 0
v_mul_f32 v224, v224, v232
v_mul_f32 v232, v225, v225
v_fma_f32 v232, v232, s40, 1.0
v_mul_f32 v232, v232, v225
v_mul_f32 v232, s41, v232
v_exp_f32 v232, v232
s_nop 0
v_add_f32 v232, 1.0, v232
v_rcp_f32 v232, v232
s_nop 0
v_mul_f32 v225, v225, v232
v_mul_f32 v232, v226, v226
v_fma_f32 v232, v232, s40, 1.0
v_mul_f32 v232, v232, v226
v_mul_f32 v232, s41, v232
v_exp_f32 v232, v232
s_nop 0
v_add_f32 v232, 1.0, v232
v_rcp_f32 v232, v232
s_nop 0
v_mul_f32 v226, v226, v232
v_mul_f32 v232, v227, v227
v_fma_f32 v232, v232, s40, 1.0
v_mul_f32 v232, v232, v227
v_mul_f32 v232, s41, v232
v_exp_f32 v232, v232
s_nop 0
v_add_f32 v232, 1.0, v232
v_rcp_f32 v232, v232
s_nop 0
v_mul_f32 v227, v227, v232
v_cvt_pk_bf16_f32 v224, v224, v225
v_cvt_pk_bf16_f32 v225, v226, v227
buffer_store_dwordx2 v[224:225], v240, s[52:55], 0 offen offset:224
s_nop 1
v_accvgpr_read_b32 v224, a32
v_cvt_pk_bf16_f32 v224, v224, v224
v_and_b32 v224, 0xffff0000, v224
v_accvgpr_read_b32 v225, a33
v_cvt_pk_bf16_f32 v225, v225, v225
v_and_b32 v225, 0xffff0000, v225
v_accvgpr_read_b32 v226, a34
v_cvt_pk_bf16_f32 v226, v226, v226
v_and_b32 v226, 0xffff0000, v226
v_accvgpr_read_b32 v227, a35
v_cvt_pk_bf16_f32 v227, v227, v227
v_and_b32 v227, 0xffff0000, v227
v_mul_f32 v232, v224, v224
v_fma_f32 v232, v232, s40, 1.0
v_mul_f32 v232, v232, v224
v_mul_f32 v232, s41, v232
v_exp_f32 v232, v232
s_nop 0
v_add_f32 v232, 1.0, v232
v_rcp_f32 v232, v232
s_nop 0
v_mul_f32 v224, v224, v232
v_mul_f32 v232, v225, v225
v_fma_f32 v232, v232, s40, 1.0
v_mul_f32 v232, v232, v225
v_mul_f32 v232, s41, v232
v_exp_f32 v232, v232
s_nop 0
v_add_f32 v232, 1.0, v232
v_rcp_f32 v232, v232
s_nop 0
v_mul_f32 v225, v225, v232
v_mul_f32 v232, v226, v226
v_fma_f32 v232, v232, s40, 1.0
v_mul_f32 v232, v232, v226
v_mul_f32 v232, s41, v232
v_exp_f32 v232, v232
s_nop 0
v_add_f32 v232, 1.0, v232
v_rcp_f32 v232, v232
s_nop 0
v_mul_f32 v226, v226, v232
v_mul_f32 v232, v227, v227
v_fma_f32 v232, v232, s40, 1.0
v_mul_f32 v232, v232, v227
v_mul_f32 v232, s41, v232
v_exp_f32 v232, v232
s_nop 0
v_add_f32 v232, 1.0, v232
v_rcp_f32 v232, v232
s_nop 0
v_mul_f32 v227, v227, v232
v_cvt_pk_bf16_f32 v224, v224, v225
v_cvt_pk_bf16_f32 v225, v226, v227
buffer_store_dwordx2 v[224:225], v240, s[52:55], 0 offen offset:256
s_nop 1
v_accvgpr_read_b32 v224, a36
v_cvt_pk_bf16_f32 v224, v224, v224
v_and_b32 v224, 0xffff0000, v224
v_accvgpr_read_b32 v225, a37
v_cvt_pk_bf16_f32 v225, v225, v225
v_and_b32 v225, 0xffff0000, v225
v_accvgpr_read_b32 v226, a38
v_cvt_pk_bf16_f32 v226, v226, v226
v_and_b32 v226, 0xffff0000, v226
v_accvgpr_read_b32 v227, a39
v_cvt_pk_bf16_f32 v227, v227, v227
v_and_b32 v227, 0xffff0000, v227
v_mul_f32 v232, v224, v224
v_fma_f32 v232, v232, s40, 1.0
v_mul_f32 v232, v232, v224
v_mul_f32 v232, s41, v232
v_exp_f32 v232, v232
s_nop 0
v_add_f32 v232, 1.0, v232
v_rcp_f32 v232, v232
s_nop 0
v_mul_f32 v224, v224, v232
v_mul_f32 v232, v225, v225
v_fma_f32 v232, v232, s40, 1.0
v_mul_f32 v232, v232, v225
v_mul_f32 v232, s41, v232
v_exp_f32 v232, v232
s_nop 0
v_add_f32 v232, 1.0, v232
v_rcp_f32 v232, v232
s_nop 0
v_mul_f32 v225, v225, v232
v_mul_f32 v232, v226, v226
v_fma_f32 v232, v232, s40, 1.0
v_mul_f32 v232, v232, v226
v_mul_f32 v232, s41, v232
v_exp_f32 v232, v232
s_nop 0
v_add_f32 v232, 1.0, v232
v_rcp_f32 v232, v232
s_nop 0
v_mul_f32 v226, v226, v232
v_mul_f32 v232, v227, v227
v_fma_f32 v232, v232, s40, 1.0
v_mul_f32 v232, v232, v227
v_mul_f32 v232, s41, v232
v_exp_f32 v232, v232
s_nop 0
v_add_f32 v232, 1.0, v232
v_rcp_f32 v232, v232
s_nop 0
v_mul_f32 v227, v227, v232
v_cvt_pk_bf16_f32 v224, v224, v225
v_cvt_pk_bf16_f32 v225, v226, v227
buffer_store_dwordx2 v[224:225], v240, s[52:55], 0 offen offset:288
s_nop 1
v_accvgpr_read_b32 v224, a40
v_cvt_pk_bf16_f32 v224, v224, v224
v_and_b32 v224, 0xffff0000, v224
v_accvgpr_read_b32 v225, a41
v_cvt_pk_bf16_f32 v225, v225, v225
v_and_b32 v225, 0xffff0000, v225
v_accvgpr_read_b32 v226, a42
v_cvt_pk_bf16_f32 v226, v226, v226
v_and_b32 v226, 0xffff0000, v226
v_accvgpr_read_b32 v227, a43
v_cvt_pk_bf16_f32 v227, v227, v227
v_and_b32 v227, 0xffff0000, v227
v_mul_f32 v232, v224, v224
v_fma_f32 v232, v232, s40, 1.0
v_mul_f32 v232, v232, v224
v_mul_f32 v232, s41, v232
v_exp_f32 v232, v232
s_nop 0
v_add_f32 v232, 1.0, v232
v_rcp_f32 v232, v232
s_nop 0
v_mul_f32 v224, v224, v232
v_mul_f32 v232, v225, v225
v_fma_f32 v232, v232, s40, 1.0
v_mul_f32 v232, v232, v225
v_mul_f32 v232, s41, v232
v_exp_f32 v232, v232
s_nop 0
v_add_f32 v232, 1.0, v232
v_rcp_f32 v232, v232
s_nop 0
v_mul_f32 v225, v225, v232
v_mul_f32 v232, v226, v226
v_fma_f32 v232, v232, s40, 1.0
v_mul_f32 v232, v232, v226
v_mul_f32 v232, s41, v232
v_exp_f32 v232, v232
s_nop 0
v_add_f32 v232, 1.0, v232
v_rcp_f32 v232, v232
s_nop 0
v_mul_f32 v226, v226, v232
v_mul_f32 v232, v227, v227
v_fma_f32 v232, v232, s40, 1.0
v_mul_f32 v232, v232, v227
v_mul_f32 v232, s41, v232
v_exp_f32 v232, v232
s_nop 0
v_add_f32 v232, 1.0, v232
v_rcp_f32 v232, v232
s_nop 0
v_mul_f32 v227, v227, v232
v_cvt_pk_bf16_f32 v224, v224, v225
v_cvt_pk_bf16_f32 v225, v226, v227
buffer_store_dwordx2 v[224:225], v240, s[52:55], 0 offen offset:320
s_nop 1
v_accvgpr_read_b32 v224, a44
v_cvt_pk_bf16_f32 v224, v224, v224
v_and_b32 v224, 0xffff0000, v224
v_accvgpr_read_b32 v225, a45
v_cvt_pk_bf16_f32 v225, v225, v225
v_and_b32 v225, 0xffff0000, v225
v_accvgpr_read_b32 v226, a46
v_cvt_pk_bf16_f32 v226, v226, v226
v_and_b32 v226, 0xffff0000, v226
v_accvgpr_read_b32 v227, a47
v_cvt_pk_bf16_f32 v227, v227, v227
v_and_b32 v227, 0xffff0000, v227
v_mul_f32 v232, v224, v224
v_fma_f32 v232, v232, s40, 1.0
v_mul_f32 v232, v232, v224
v_mul_f32 v232, s41, v232
v_exp_f32 v232, v232
s_nop 0
v_add_f32 v232, 1.0, v232
v_rcp_f32 v232, v232
s_nop 0
v_mul_f32 v224, v224, v232
v_mul_f32 v232, v225, v225
v_fma_f32 v232, v232, s40, 1.0
v_mul_f32 v232, v232, v225
v_mul_f32 v232, s41, v232
v_exp_f32 v232, v232
s_nop 0
v_add_f32 v232, 1.0, v232
v_rcp_f32 v232, v232
s_nop 0
v_mul_f32 v225, v225, v232
v_mul_f32 v232, v226, v226
v_fma_f32 v232, v232, s40, 1.0
v_mul_f32 v232, v232, v226
v_mul_f32 v232, s41, v232
v_exp_f32 v232, v232
s_nop 0
v_add_f32 v232, 1.0, v232
v_rcp_f32 v232, v232
s_nop 0
v_mul_f32 v226, v226, v232
v_mul_f32 v232, v227, v227
v_fma_f32 v232, v232, s40, 1.0
v_mul_f32 v232, v232, v227
v_mul_f32 v232, s41, v232
v_exp_f32 v232, v232
s_nop 0
v_add_f32 v232, 1.0, v232
v_rcp_f32 v232, v232
s_nop 0
v_mul_f32 v227, v227, v232
v_cvt_pk_bf16_f32 v224, v224, v225
v_cvt_pk_bf16_f32 v225, v226, v227
buffer_store_dwordx2 v[224:225], v240, s[52:55], 0 offen offset:352
s_nop 1
k5_kernel_end:
s_endpgm
.p2align 8
.globl k6_kernel
.type k6_kernel,@function
k6_kernel:
s_cmp_ge_u32 s2, 256
s_cbranch_scc1 k6_kernel_end
s_load_dwordx16 s[16:31], s[0:1], 0
s_load_dwordx4 s[32:35], s[0:1], 64
s_load_dwordx2 s[36:37], s[0:1], 80
s_mov_b32 s40, 0x3d372713
s_mov_b32 s41, 0xc0135761
s_mov_b32 s42, 0x3acccccd
v_and_b32 v252, 63, v0
v_lshrrev_b32 v253, 6, v0
s_nop 0
v_readfirstlane_b32 s3, v253
v_and_b32 v253, 15, v252
v_lshrrev_b32 v254, 4, v252
v_xor_b32 v250, 16, v252
v_lshlrev_b32 v250, 2, v250
v_xor_b32 v251, 32, v252
v_lshlrev_b32 v251, 2, v251
s_and_b32 s4, s2, 7
s_lshl_b32 s4, s4, 2
s_lshr_b32 s5, s2, 3
s_and_b32 s6, s5, 3
s_add_u32 s4, s4, s6
s_lshr_b32 s5, s5, 2
s_lshl_b32 s6, s4, 6
s_lshl_b32 s7, s3, 4
s_add_u32 s6, s6, s7
v_add_u32 v255, s6, v253
s_waitcnt lgkmcnt(0)
s_add_u32 s44, s36, 15728640
s_addc_u32 s45, s37, 0
s_mov_b32 s46, 6291456
s_mov_b32 s47, 0x00020000
s_mov_b32 s48, s30
s_mov_b32 s49, s31
s_mov_b32 s50, 1966080
s_mov_b32 s51, 0x00020000
s_mul_i32 s8, s3, 5120
v_lshlrev_b32 v240, 4, v252
v_add_u32 v240, s8, v240
v_add_u32 v240, 0, v240
v_cvt_f32_u32 v241, v240
s_mov_b32 s9, 0x3bcccccd
v_add_f32 v241, 0.5, v241
v_mul_f32 v241, s9, v241
v_cvt_u32_f32 v241, v241
s_movk_i32 s9, 160
v_mul_lo_u32 v242, v241, s9
v_sub_u32 v242, v240, v242
s_movk_i32 s9, 1280
v_mad_u32_u24 v192, v241, s9, v242
s_mul_i32 s8, s3, 5120
v_lshlrev_b32 v240, 4, v252
v_add_u32 v240, s8, v240
v_add_u32 v240, 1024, v240
v_cvt_f32_u32 v241, v240
s_mov_b32 s9, 0x3bcccccd
v_add_f32 v241, 0.5, v241
v_mul_f32 v241, s9, v241
v_cvt_u32_f32 v241, v241
s_movk_i32 s9, 160
v_mul_lo_u32 v242, v241, s9
v_sub_u32 v242, v240, v242
s_movk_i32 s9, 1280
v_mad_u32_u24 v193, v241, s9, v242
s_mul_i32 s8, s3, 5120
v_lshlrev_b32 v240, 4, v252
v_add_u32 v240, s8, v240
v_add_u32 v240, 2048, v240
v_cvt_f32_u32 v241, v240
s_mov_b32 s9, 0x3bcccccd
v_add_f32 v241, 0.5, v241
v_mul_f32 v241, s9, v241
v_cvt_u32_f32 v241, v241
s_movk_i32 s9, 160
v_mul_lo_u32 v242, v241, s9
v_sub_u32 v242, v240, v242
s_movk_i32 s9, 1280
v_mad_u32_u24 v194, v241, s9, v242
s_mul_i32 s8, s3, 5120
v_lshlrev_b32 v240, 4, v252
v_add_u32 v240, s8, v240
v_add_u32 v240, 3072, v240
v_cvt_f32_u32 v241, v240
s_mov_b32 s9, 0x3bcccccd
v_add_f32 v241, 0.5, v241
v_mul_f32 v241, s9, v241
v_cvt_u32_f32 v241, v241
s_movk_i32 s9, 160
v_mul_lo_u32 v242, v241, s9
v_sub_u32 v242, v240, v242
s_movk_i32 s9, 1280
v_mad_u32_u24 v195, v241, s9, v242
s_mul_i32 s8, s3, 5120
v_lshlrev_b32 v240, 4, v252
v_add_u32 v240, s8, v240
v_add_u32 v240, 4096, v240
v_cvt_f32_u32 v241, v240
s_mov_b32 s9, 0x3bcccccd
v_add_f32 v241, 0.5, v241
v_mul_f32 v241, s9, v241
v_cvt_u32_f32 v241, v241
s_movk_i32 s9, 160
v_mul_lo_u32 v242, v241, s9
v_sub_u32 v242, v240, v242
s_movk_i32 s9, 1280
v_mad_u32_u24 v196, v241, s9, v242
s_mul_i32 s10, s5, 160
s_mul_i32 s13, s3, 5120
s_add_u32 s13, s13, 0
s_mov_b32 s14, 0
v_and_b32 v240, 1, v254
v_mov_b32 v241, 0
v_lshl_add_u32 v241, v254, 4, v241
s_movk_i32 s9, 3072
v_mad_u32_u24 v248, v255, s9, v241
v_mov_b32 v241, 8
v_lshl_add_u32 v241, v254, 4, v241
s_movk_i32 s9, 3072
v_mad_u32_u24 v249, v255, s9, v241
s_mul_i32 s12, s5, 160
v_lshlrev_b32 v241, 3, v254
v_add_u32 v241, s12, v241
s_movk_i32 s9, 1280
v_mad_u32_u24 v240, v255, s9, v241
s_add_u32 s56, s36, 13107200
s_addc_u32 s57, s37, 0
s_mov_b32 s58, 2621440
s_mov_b32 s59, 0x00020000
s_add_u32 s60, s36, 5242880
s_addc_u32 s61, s37, 0
s_mov_b32 s62, 2621440
s_mov_b32 s63, 0x00020000
buffer_load_dwordx2 a[64:65], v240, s[56:59], 0 offen offset:0
buffer_load_dwordx2 a[96:97], v240, s[60:63], 0 offen offset:0
buffer_load_dwordx2 a[66:67], v240, s[56:59], 0 offen offset:32
buffer_load_dwordx2 a[98:99], v240, s[60:63], 0 offen offset:32
buffer_load_dwordx2 a[68:69], v240, s[56:59], 0 offen offset:64
buffer_load_dwordx2 a[100:101], v240, s[60:63], 0 offen offset:64
buffer_load_dwordx2 a[70:71], v240, s[56:59], 0 offen offset:96
buffer_load_dwordx2 a[102:103], v240, s[60:63], 0 offen offset:96
buffer_load_dwordx2 a[72:73], v240, s[56:59], 0 offen offset:128
buffer_load_dwordx2 a[104:105], v240, s[60:63], 0 offen offset:128
v_accvgpr_write_b32 a0, 0
v_accvgpr_write_b32 a1, 0
v_accvgpr_write_b32 a2, 0
v_accvgpr_write_b32 a3, 0
v_accvgpr_write_b32 a4, 0
v_accvgpr_write_b32 a5, 0
v_accvgpr_write_b32 a6, 0
v_accvgpr_write_b32 a7, 0
v_accvgpr_write_b32 a8, 0
v_accvgpr_write_b32 a9, 0
v_accvgpr_write_b32 a10, 0
v_accvgpr_write_b32 a11, 0
v_accvgpr_write_b32 a12, 0
v_accvgpr_write_b32 a13, 0
v_accvgpr_write_b32 a14, 0
v_accvgpr_write_b32 a15, 0
v_accvgpr_write_b32 a16, 0
v_accvgpr_write_b32 a17, 0
v_accvgpr_write_b32 a18, 0
v_accvgpr_write_b32 a19, 0
v_lshlrev_b32 v236, 4, v252
s_mul_i32 s8, s3, 20480
v_add_u32 v236, s8, v236
s_add_u32 s8, s13, s14
s_add_u32 m0, s8, 0
s_nop 0
buffer_load_dwordx4 v192, s[48:51], s10 offen lds
s_add_u32 s8, s13, s14
s_add_u32 m0, s8, 1024
s_nop 0
buffer_load_dwordx4 v193, s[48:51], s10 offen lds
s_add_u32 s8, s13, s14
s_add_u32 m0, s8, 2048
s_nop 0
buffer_load_dwordx4 v194, s[48:51], s10 offen lds
s_add_u32 s8, s13, s14
s_add_u32 m0, s8, 3072
s_nop 0
buffer_load_dwordx4 v195, s[48:51], s10 offen lds
s_add_u32 s8, s13, s14
s_add_u32 m0, s8, 4096
s_nop 0
buffer_load_dwordx4 v196, s[48:51], s10 offen lds
s_add_u32 s10, s10, 163840
s_add_u32 s14, s14, 20480
s_cmp_ge_u32 s14, 81920
s_cselect_b32 s14, 0, s14
s_add_u32 s8, s13, s14
s_add_u32 m0, s8, 0
s_nop 0
buffer_load_dwordx4 v192, s[48:51], s10 offen lds
s_add_u32 s8, s13, s14
s_add_u32 m0, s8, 1024
s_nop 0
buffer_load_dwordx4 v193, s[48:51], s10 offen lds
s_add_u32 s8, s13, s14
s_add_u32 m0, s8, 2048
s_nop 0
buffer_load_dwordx4 v194, s[48:51], s10 offen lds
s_add_u32 s8, s13, s14
s_add_u32 m0, s8, 3072
s_nop 0
buffer_load_dwordx4 v195, s[48:51], s10 offen lds
s_add_u32 s8, s13, s14
s_add_u32 m0, s8, 4096
s_nop 0
buffer_load_dwordx4 v196, s[48:51], s10 offen lds
s_add_u32 s10, s10, 163840
s_add_u32 s14, s14, 20480
s_cmp_ge_u32 s14, 81920
s_cselect_b32 s14, 0, s14
s_add_u32 s8, s13, s14
s_add_u32 m0, s8, 0
s_nop 0
buffer_load_dwordx4 v192, s[48:51], s10 offen lds
s_add_u32 s8, s13, s14
s_add_u32 m0, s8, 1024
s_nop 0
buffer_load_dwordx4 v193, s[48:51], s10 offen lds
s_add_u32 s8, s13, s14
s_add_u32 m0, s8, 2048
s_nop 0
buffer_load_dwordx4 v194, s[48:51], s10 offen lds
s_add_u32 s8, s13, s14
s_add_u32 m0, s8, 3072
s_nop 0
buffer_load_dwordx4 v195, s[48:51], s10 offen lds
s_add_u32 s8, s13, s14
s_add_u32 m0, s8, 4096
s_nop 0
buffer_load_dwordx4 v196, s[48:51], s10 offen lds
s_add_u32 s10, s10, 163840
s_add_u32 s14, s14, 20480
s_cmp_ge_u32 s14, 81920
s_cselect_b32 s14, 0, s14
buffer_load_dwordx4 v[0:3], v248, s[44:47], 0 offen offset:0
buffer_load_dwordx4 v[4:7], v248, s[44:47], 0 offen offset:64
buffer_load_dwordx4 v[8:11], v248, s[44:47], 0 offen offset:128
buffer_load_dwordx4 v[12:15], v248, s[44:47], 0 offen offset:192
v_and_b32 v240, 1, v254
v_lshrrev_b32 v241, 2, v253
v_and_b32 v242, 3, v253
v_lshlrev_b32 v242, 3, v242
v_add_u32 v242, 0, v242
v_mov_b32 v243, 0
v_lshl_add_u32 v243, v254, 3, v243
v_add_u32 v243, v243, v241
s_movk_i32 s9, 160
v_mad_u32_u24 v244, v243, s9, v242
v_mov_b32 v243, 4
v_lshl_add_u32 v243, v254, 3, v243
v_add_u32 v243, v243, v241
s_movk_i32 s9, 160
v_mad_u32_u24 v245, v243, s9, v242
s_mov_b32 s15, 0
s_mov_b32 s12, 0
k6_kernel_L:
s_waitcnt vmcnt(0)
s_barrier
v_mov_b32 v32, v0
v_mov_b32 v33, v1
v_mov_b32 v34, v2
v_mov_b32 v35, v3
v_mov_b32 v36, v4
v_mov_b32 v37, v5
v_mov_b32 v38, v6
v_mov_b32 v39, v7
v_mov_b32 v40, v8
v_mov_b32 v41, v9
v_mov_b32 v42, v10
v_mov_b32 v43, v11
v_mov_b32 v44, v12
v_mov_b32 v45, v13
v_mov_b32 v46, v14
v_mov_b32 v47, v15
v_add_u32 v248, 256, v248
v_add_u32 v249, 256, v249
buffer_load_dwordx4 v[0:3], v248, s[44:47], 0 offen offset:0
buffer_load_dwordx4 v[4:7], v248, s[44:47], 0 offen offset:64
buffer_load_dwordx4 v[8:11], v248, s[44:47], 0 offen offset:128
buffer_load_dwordx4 v[12:15], v248, s[44:47], 0 offen offset:192
s_add_u32 s8, s13, s14
s_add_u32 m0, s8, 0
s_nop 0
buffer_load_dwordx4 v192, s[48:51], s10 offen lds
s_add_u32 s8, s13, s14
s_add_u32 m0, s8, 1024
s_nop 0
buffer_load_dwordx4 v193, s[48:51], s10 offen lds
s_add_u32 s8, s13, s14
s_add_u32 m0, s8, 2048
s_nop 0
buffer_load_dwordx4 v194, s[48:51], s10 offen lds
s_add_u32 s8, s13, s14
s_add_u32 m0, s8, 3072
s_nop 0
buffer_load_dwordx4 v195, s[48:51], s10 offen lds
s_add_u32 s8, s13, s14
s_add_u32 m0, s8, 4096
s_nop 0
buffer_load_dwordx4 v196, s[48:51], s10 offen lds
s_add_u32 s10, s10, 163840
s_add_u32 s14, s14, 20480
s_cmp_ge_u32 s14, 81920
s_cselect_b32 s14, 0, s14
v_add_u32 v246, s15, v244
v_add_u32 v247, s15, v245
ds_read_b64_tr_b16 v[144:145], v246 offset:0
ds_read_b64_tr_b16 v[146:147], v247 offset:0
ds_read_b64_tr_b16 v[148:149], v246 offset:32
ds_read_b64_tr_b16 v[150:151], v247 offset:32
ds_read_b64_tr_b16 v[152:153], v246 offset:64
ds_read_b64_tr_b16 v[154:155], v247 offset:64
ds_read_b64_tr_b16 v[156:157], v246 offset:96
ds_read_b64_tr_b16 v[158:159], v247 offset:96
ds_read_b64_tr_b16 v[160:161], v246 offset:128
ds_read_b64_tr_b16 v[162:163], v247 offset:128
ds_read_b64_tr_b16 v[164:165], v246 offset:5120
ds_read_b64_tr_b16 v[166:167], v247 offset:5120
s_waitcnt lgkmcnt(10)
s_nop 1
v_mfma_f32_16x16x32_bf16 a[0:3], v[144:147], v[32:35], a[0:3]
ds_read_b64_tr_b16 v[168:169], v246 offset:5152
ds_read_b64_tr_b16 v[170:171], v247 offset:5152
s_waitcnt lgkmcnt(10)
v_mfma_f32_16x16x32_bf16 a[4:7], v[148:151], v[32:35], a[4:7]
ds_read_b64_tr_b16 v[144:145], v246 offset:5184
ds_read_b64_tr_b16 v[146:147], v247 offset:5184
s_waitcnt lgkmcnt(10)
v_mfma_f32_16x16x32_bf16 a[8:11], v[152:155], v[32:35], a[8:11]
ds_read_b64_tr_b16 v[148:149], v246 offset:5216
ds_read_b64_tr_b16 v[150:151], v247 offset:5216
s_waitcnt lgkmcnt(10)
v_mfma_f32_16x16x32_bf16 a[12:15], v[156:159], v[32:35], a[12:15]
ds_read_b64_tr_b16 v[152:153], v246 offset:5248
ds_read_b64_tr_b16 v[154:155], v247 offset:5248
s_waitcnt lgkmcnt(10)
v_mfma_f32_16x16x32_bf16 a[16:19], v[160:163], v[32:35], a[16:19]
ds_read_b64_tr_b16 v[156:157], v246 offset:10240
ds_read_b64_tr_b16 v[158:159], v247 offset:10240
s_waitcnt lgkmcnt(10)
v_mfma_f32_16x16x32_bf16 a[0:3], v[164:167], v[36:39], a[0:3]
ds_read_b64_tr_b16 v[160:161], v246 offset:10272
ds_read_b64_tr_b16 v[162:163], v247 offset:10272
s_waitcnt lgkmcnt(10)
v_mfma_f32_16x16x32_bf16 a[4:7], v[168:171], v[36:39], a[4:7]
ds_read_b64_tr_b16 v[164:165], v246 offset:10304
ds_read_b64_tr_b16 v[166:167], v247 offset:10304
s_waitcnt lgkmcnt(10)
v_mfma_f32_16x16x32_bf16 a[8:11], v[144:147], v[36:39], a[8:11]
ds_read_b64_tr_b16 v[168:169], v246 offset:10336
ds_read_b64_tr_b16 v[170:171], v247 offset:10336
s_waitcnt lgkmcnt(10)
v_mfma_f32_16x16x32_bf16 a[12:15], v[148:151], v[36:39], a[12:15]
ds_read_b64_tr_b16 v[144:145], v246 offset:10368
ds_read_b64_tr_b16 v[146:147], v247 offset:10368
s_waitcnt lgkmcnt(10)
v_mfma_f32_16x16x32_bf16 a[16:19], v[152:155], v[36:39], a[16:19]
ds_read_b64_tr_b16 v[148:149], v246 offset:15360
ds_read_b64_tr_b16 v[150:151], v247 offset:15360
s_waitcnt lgkmcnt(10)
v_mfma_f32_16x16x32_bf16 a[0:3], v[156:159], v[40:43], a[0:3]
ds_read_b64_tr_b16 v[152:153], v246 offset:15392
ds_read_b64_tr_b16 v[154:155], v247 offset:15392
s_waitcnt lgkmcnt(10)
v_mfma_f32_16x16x32_bf16 a[4:7], v[160:163], v[40:43], a[4:7]
ds_read_b64_tr_b16 v[156:157], v246 offset:15424
ds_read_b64_tr_b16 v[158:159], v247 offset:15424
s_waitcnt lgkmcnt(10)
v_mfma_f32_16x16x32_bf16 a[8:11], v[164:167], v[40:43], a[8:11]
ds_read_b64_tr_b16 v[160:161], v246 offset:15456
ds_read_b64_tr_b16 v[162:163], v247 offset:15456
s_waitcnt lgkmcnt(10)
v_mfma_f32_16x16x32_bf16 a[12:15], v[168:171], v[40:43], a[12:15]
ds_read_b64_tr_b16 v[164:165], v246 offset:15488
ds_read_b64_tr_b16 v[166:167], v247 offset:15488
s_waitcnt lgkmcnt(10)
v_mfma_f32_16x16x32_bf16 a[16:19], v[144:147], v[40:43], a[16:19]
s_waitcnt lgkmcnt(8)
v_mfma_f32_16x16x32_bf16 a[0:3], v[148:151], v[44:47], a[0:3]
s_waitcnt lgkmcnt(6)
v_mfma_f32_16x16x32_bf16 a[4:7], v[152:155], v[44:47], a[4:7]
s_waitcnt lgkmcnt(4)
v_mfma_f32_16x16x32_bf16 a[8:11], v[156:159], v[44:47], a[8:11]
s_waitcnt lgkmcnt(2)
v_mfma_f32_16x16x32_bf16 a[12:15], v[160:163], v[44:47], a[12:15]
s_waitcnt lgkmcnt(0)
v_mfma_f32_16x16x32_bf16 a[16:19], v[164:167], v[44:47], a[16:19]
s_add_u32 s15, s15, 20480
s_cmp_ge_u32 s15, 81920
s_cselect_b32 s15, 0, s15
s_add_u32 s12, s12, 4096
s_cmp_lt_u32 s12, 49152
s_cbranch_scc1 k6_kernel_L
s_waitcnt vmcnt(0)
s_nop 7
s_nop 7
s_mul_i32 s10, s5, 160
v_lshlrev_b32 v241, 3, v254
v_add_u32 v241, s10, v241
s_movk_i32 s9, 1280
v_mad_u32_u24 v240, v255, s9, v241
s_mov_b32 s52, s32
s_mov_b32 s53, s33
s_mov_b32 s54, 2621440
s_mov_b32 s55, 0x00020000
s_add_u32 s56, s36, 13107200
s_addc_u32 s57, s37, 0
s_mov_b32 s58, 2621440
s_mov_b32 s59, 0x00020000
s_add_u32 s60, s36, 5242880
s_addc_u32 s61, s37, 0
s_mov_b32 s62, 2621440
s_mov_b32 s63, 0x00020000
v_accvgpr_read_b32 v228, a64
v_accvgpr_read_b32 v229, a65
v_accvgpr_read_b32 v230, a96
v_accvgpr_read_b32 v231, a97
v_accvgpr_read_b32 v224, a0
v_cvt_pk_bf16_f32 v224, v224, v224
v_and_b32 v224, 0xffff0000, v224
v_accvgpr_read_b32 v225, a1
v_cvt_pk_bf16_f32 v225, v225, v225
v_and_b32 v225, 0xffff0000, v225
v_accvgpr_read_b32 v226, a2
v_cvt_pk_bf16_f32 v226, v226, v226
v_and_b32 v226, 0xffff0000, v226
v_accvgpr_read_b32 v227, a3
v_cvt_pk_bf16_f32 v227, v227, v227
v_and_b32 v227, 0xffff0000, v227
v_lshlrev_b32 v232, 16, v228
v_and_b32 v233, 0xffff0000, v228
v_add_f32 v224, v224, v232
v_add_f32 v225, v225, v233
v_cvt_pk_bf16_f32 v224, v224, v224
v_and_b32 v224, 0xffff0000, v224
v_cvt_pk_bf16_f32 v225, v225, v225
v_and_b32 v225, 0xffff0000, v225
v_lshlrev_b32 v232, 16, v230
v_and_b32 v233, 0xffff0000, v230
v_add_f32 v224, v224, v232
v_add_f32 v225, v225, v233
v_lshlrev_b32 v232, 16, v229
v_and_b32 v233, 0xffff0000, v229
v_add_f32 v226, v226, v232
v_add_f32 v227, v227, v233
v_cvt_pk_bf16_f32 v226, v226, v226
v_and_b32 v226, 0xffff0000, v226
v_cvt_pk_bf16_f32 v227, v227, v227
v_and_b32 v227, 0xffff0000, v227
v_lshlrev_b32 v232, 16, v231
v_and_b32 v233, 0xffff0000, v231
v_add_f32 v226, v226, v232
v_add_f32 v227, v227, v233
v_cvt_pk_bf16_f32 v224, v224, v225
v_cvt_pk_bf16_f32 v225, v226, v227
buffer_store_dwordx2 v[224:225], v240, s[52:55], 0 offen offset:0
s_nop 1
v_accvgpr_read_b32 v228, a66
v_accvgpr_read_b32 v229, a67
v_accvgpr_read_b32 v230, a98
v_accvgpr_read_b32 v231, a99
v_accvgpr_read_b32 v224, a4
v_cvt_pk_bf16_f32 v224, v224, v224
v_and_b32 v224, 0xffff0000, v224
v_accvgpr_read_b32 v225, a5
v_cvt_pk_bf16_f32 v225, v225, v225
v_and_b32 v225, 0xffff0000, v225
v_accvgpr_read_b32 v226, a6
v_cvt_pk_bf16_f32 v226, v226, v226
v_and_b32 v226, 0xffff0000, v226
v_accvgpr_read_b32 v227, a7
v_cvt_pk_bf16_f32 v227, v227, v227
v_and_b32 v227, 0xffff0000, v227
v_lshlrev_b32 v232, 16, v228
v_and_b32 v233, 0xffff0000, v228
v_add_f32 v224, v224, v232
v_add_f32 v225, v225, v233
v_cvt_pk_bf16_f32 v224, v224, v224
v_and_b32 v224, 0xffff0000, v224
v_cvt_pk_bf16_f32 v225, v225, v225
v_and_b32 v225, 0xffff0000, v225
v_lshlrev_b32 v232, 16, v230
v_and_b32 v233, 0xffff0000, v230
v_add_f32 v224, v224, v232
v_add_f32 v225, v225, v233
v_lshlrev_b32 v232, 16, v229
v_and_b32 v233, 0xffff0000, v229
v_add_f32 v226, v226, v232
v_add_f32 v227, v227, v233
v_cvt_pk_bf16_f32 v226, v226, v226
v_and_b32 v226, 0xffff0000, v226
v_cvt_pk_bf16_f32 v227, v227, v227
v_and_b32 v227, 0xffff0000, v227
v_lshlrev_b32 v232, 16, v231
v_and_b32 v233, 0xffff0000, v231
v_add_f32 v226, v226, v232
v_add_f32 v227, v227, v233
v_cvt_pk_bf16_f32 v224, v224, v225
v_cvt_pk_bf16_f32 v225, v226, v227
buffer_store_dwordx2 v[224:225], v240, s[52:55], 0 offen offset:32
s_nop 1
v_accvgpr_read_b32 v228, a68
v_accvgpr_read_b32 v229, a69
v_accvgpr_read_b32 v230, a100
v_accvgpr_read_b32 v231, a101
v_accvgpr_read_b32 v224, a8
v_cvt_pk_bf16_f32 v224, v224, v224
v_and_b32 v224, 0xffff0000, v224
v_accvgpr_read_b32 v225, a9
v_cvt_pk_bf16_f32 v225, v225, v225
v_and_b32 v225, 0xffff0000, v225
v_accvgpr_read_b32 v226, a10
v_cvt_pk_bf16_f32 v226, v226, v226
v_and_b32 v226, 0xffff0000, v226
v_accvgpr_read_b32 v227, a11
v_cvt_pk_bf16_f32 v227, v227, v227
v_and_b32 v227, 0xffff0000, v227
v_lshlrev_b32 v232, 16, v228
v_and_b32 v233, 0xffff0000, v228
v_add_f32 v224, v224, v232
v_add_f32 v225, v225, v233
v_cvt_pk_bf16_f32 v224, v224, v224
v_and_b32 v224, 0xffff0000, v224
v_cvt_pk_bf16_f32 v225, v225, v225
v_and_b32 v225, 0xffff0000, v225
v_lshlrev_b32 v232, 16, v230
v_and_b32 v233, 0xffff0000, v230
v_add_f32 v224, v224, v232
v_add_f32 v225, v225, v233
v_lshlrev_b32 v232, 16, v229
v_and_b32 v233, 0xffff0000, v229
v_add_f32 v226, v226, v232
v_add_f32 v227, v227, v233
v_cvt_pk_bf16_f32 v226, v226, v226
v_and_b32 v226, 0xffff0000, v226
v_cvt_pk_bf16_f32 v227, v227, v227
v_and_b32 v227, 0xffff0000, v227
v_lshlrev_b32 v232, 16, v231
v_and_b32 v233, 0xffff0000, v231
v_add_f32 v226, v226, v232
v_add_f32 v227, v227, v233
v_cvt_pk_bf16_f32 v224, v224, v225
v_cvt_pk_bf16_f32 v225, v226, v227
buffer_store_dwordx2 v[224:225], v240, s[52:55], 0 offen offset:64
s_nop 1
v_accvgpr_read_b32 v228, a70
v_accvgpr_read_b32 v229, a71
v_accvgpr_read_b32 v230, a102
v_accvgpr_read_b32 v231, a103
v_accvgpr_read_b32 v224, a12
v_cvt_pk_bf16_f32 v224, v224, v224
v_and_b32 v224, 0xffff0000, v224
v_accvgpr_read_b32 v225, a13
v_cvt_pk_bf16_f32 v225, v225, v225
v_and_b32 v225, 0xffff0000, v225
v_accvgpr_read_b32 v226, a14
v_cvt_pk_bf16_f32 v226, v226, v226
v_and_b32 v226, 0xffff0000, v226
v_accvgpr_read_b32 v227, a15
v_cvt_pk_bf16_f32 v227, v227, v227
v_and_b32 v227, 0xffff0000, v227
v_lshlrev_b32 v232, 16, v228
v_and_b32 v233, 0xffff0000, v228
v_add_f32 v224, v224, v232
v_add_f32 v225, v225, v233
v_cvt_pk_bf16_f32 v224, v224, v224
v_and_b32 v224, 0xffff0000, v224
v_cvt_pk_bf16_f32 v225, v225, v225
v_and_b32 v225, 0xffff0000, v225
v_lshlrev_b32 v232, 16, v230
v_and_b32 v233, 0xffff0000, v230
v_add_f32 v224, v224, v232
v_add_f32 v225, v225, v233
v_lshlrev_b32 v232, 16, v229
v_and_b32 v233, 0xffff0000, v229
v_add_f32 v226, v226, v232
v_add_f32 v227, v227, v233
v_cvt_pk_bf16_f32 v226, v226, v226
v_and_b32 v226, 0xffff0000, v226
v_cvt_pk_bf16_f32 v227, v227, v227
v_and_b32 v227, 0xffff0000, v227
v_lshlrev_b32 v232, 16, v231
v_and_b32 v233, 0xffff0000, v231
v_add_f32 v226, v226, v232
v_add_f32 v227, v227, v233
v_cvt_pk_bf16_f32 v224, v224, v225
v_cvt_pk_bf16_f32 v225, v226, v227
buffer_store_dwordx2 v[224:225], v240, s[52:55], 0 offen offset:96
s_nop 1
v_accvgpr_read_b32 v228, a72
v_accvgpr_read_b32 v229, a73
v_accvgpr_read_b32 v230, a104
v_accvgpr_read_b32 v231, a105
v_accvgpr_read_b32 v224, a16
v_cvt_pk_bf16_f32 v224, v224, v224
v_and_b32 v224, 0xffff0000, v224
v_accvgpr_read_b32 v225, a17
v_cvt_pk_bf16_f32 v225, v225, v225
v_and_b32 v225, 0xffff0000, v225
v_accvgpr_read_b32 v226, a18
v_cvt_pk_bf16_f32 v226, v226, v226
v_and_b32 v226, 0xffff0000, v226
v_accvgpr_read_b32 v227, a19
v_cvt_pk_bf16_f32 v227, v227, v227
v_and_b32 v227, 0xffff0000, v227
v_lshlrev_b32 v232, 16, v228
v_and_b32 v233, 0xffff0000, v228
v_add_f32 v224, v224, v232
v_add_f32 v225, v225, v233
v_cvt_pk_bf16_f32 v224, v224, v224
v_and_b32 v224, 0xffff0000, v224
v_cvt_pk_bf16_f32 v225, v225, v225
v_and_b32 v225, 0xffff0000, v225
v_lshlrev_b32 v232, 16, v230
v_and_b32 v233, 0xffff0000, v230
v_add_f32 v224, v224, v232
v_add_f32 v225, v225, v233
v_lshlrev_b32 v232, 16, v229
v_and_b32 v233, 0xffff0000, v229
v_add_f32 v226, v226, v232
v_add_f32 v227, v227, v233
v_cvt_pk_bf16_f32 v226, v226, v226
v_and_b32 v226, 0xffff0000, v226
v_cvt_pk_bf16_f32 v227, v227, v227
v_and_b32 v227, 0xffff0000, v227
v_lshlrev_b32 v232, 16, v231
v_and_b32 v233, 0xffff0000, v231
v_add_f32 v226, v226, v232
v_add_f32 v227, v227, v233
v_cvt_pk_bf16_f32 v224, v224, v225
v_cvt_pk_bf16_f32 v225, v226, v227
buffer_store_dwordx2 v[224:225], v240, s[52:55], 0 offen offset:128
s_nop 1
k6_kernel_end:
s_endpgm
.section .rodata,"a"
.p2align 6
.amdhsa_kernel k1_kernel
  .amdhsa_next_free_vgpr 512
  .amdhsa_next_free_sgpr 102
  .amdhsa_accum_offset 256
  .amdhsa_group_segment_fixed_size 0
  .amdhsa_kernarg_size 88
  .amdhsa_user_sgpr_count 2
  .amdhsa_user_sgpr_kernarg_segment_ptr 1
  .amdhsa_system_sgpr_workgroup_id_x 1
.end_amdhsa_kernel
.p2align 6
.amdhsa_kernel k1b_kernel
  .amdhsa_next_free_vgpr 512
  .amdhsa_next_free_sgpr 102
  .amdhsa_accum_offset 256
  .amdhsa_group_segment_fixed_size 0
  .amdhsa_kernarg_size 88
  .amdhsa_user_sgpr_count 2
  .amdhsa_user_sgpr_kernarg_segment_ptr 1
  .amdhsa_system_sgpr_workgroup_id_x 1
.end_amdhsa_kernel
.p2align 6
.amdhsa_kernel k2_kernel
  .amdhsa_next_free_vgpr 512
  .amdhsa_next_free_sgpr 102
  .amdhsa_accum_offset 256
  .amdhsa_group_segment_fixed_size 0
  .amdhsa_kernarg_size 88
  .amdhsa_user_sgpr_count 2
  .amdhsa_user_sgpr_kernarg_segment_ptr 1
  .amdhsa_system_sgpr_workgroup_id_x 1
.end_amdhsa_kernel
.p2align 6
.amdhsa_kernel k3_kernel
  .amdhsa_next_free_vgpr 512
  .amdhsa_next_free_sgpr 102
  .amdhsa_accum_offset 256
  .amdhsa_group_segment_fixed_size 0
  .amdhsa_kernarg_size 88
  .amdhsa_user_sgpr_count 2
  .amdhsa_user_sgpr_kernarg_segment_ptr 1
  .amdhsa_system_sgpr_workgroup_id_x 1
.end_amdhsa_kernel
.p2align 6
.amdhsa_kernel k4_kernel
  .amdhsa_next_free_vgpr 512
  .amdhsa_next_free_sgpr 102
  .amdhsa_accum_offset 256
  .amdhsa_group_segment_fixed_size 0
  .amdhsa_kernarg_size 88
  .amdhsa_user_sgpr_count 2
  .amdhsa_user_sgpr_kernarg_segment_ptr 1
  .amdhsa_system_sgpr_workgroup_id_x 1
.end_amdhsa_kernel
.p2align 6
.amdhsa_kernel k5_kernel
  .amdhsa_next_free_vgpr 512
  .amdhsa_next_free_sgpr 102
  .amdhsa_accum_offset 256
  .amdhsa_group_segment_fixed_size 0
  .amdhsa_kernarg_size 88
  .amdhsa_user_sgpr_count 2
  .amdhsa_user_sgpr_kernarg_segment_ptr 1
  .amdhsa_system_sgpr_workgroup_id_x 1
.end_amdhsa_kernel
.p2align 6
.amdhsa_kernel k6_kernel
  .amdhsa_next_free_vgpr 512
  .amdhsa_next_free_sgpr 102
  .amdhsa_accum_offset 256
  .amdhsa_group_segment_fixed_size 0
  .amdhsa_kernarg_size 88
  .amdhsa_user_sgpr_count 2
  .amdhsa_user_sgpr_kernarg_segment_ptr 1
  .amdhsa_system_sgpr_workgroup_id_x 1
.end_amdhsa_kernel
```
